```python
import torch

def _softmax(x, axis=-1):
    return torch.softmax(x, dim=axis)
def _gelu(x):
    return torch.nn.functional.gelu(x, approximate="tanh")
def _silu(x):
    return torch.nn.functional.silu(x)
def _sigmoid(x):
    return torch.sigmoid(x)
def _layernorm(x, axis=-1, eps=1e-5):
    m = x.mean(dim=axis, keepdim=True)
    v = x.var(dim=axis, keepdim=True, unbiased=False)
    return (x - m) / torch.sqrt(v + eps)
def _scatter_add(tgt, idx, src, axis=0):
    return tgt.clone().index_add_(axis, idx, src)
def _segment_sum(src, seg, n):
    out = torch.zeros((n,) + src.shape[1:], dtype=src.dtype)
    return out.index_add_(0, seg, src)
def _pad(x, pw):
    flat = tuple(v for pair in reversed(pw) for v in pair)
    return torch.nn.functional.pad(x, flat)

kernel_name = 'parallel_sum__linear_kernel_hedgehog__dense_activation_gelu__prompt'

def setup_inputs():

    _w = (lambda a: (lambda t: t.to(torch.bfloat16) if t.is_floating_point() else t)(torch.as_tensor(a)))
    def _A_setup():
        B, S, D, H = 1, 2048, 512, 32
        Dh = D // H
        return {
            "x": _w((lambda *s: torch.randn(*s, dtype=torch.bfloat16) * 0.05)(B, S, D)),
            "wqkv": _w((lambda *s: torch.randn(*s, dtype=torch.bfloat16) * 0.2)(D, 3 * D)),
            "w_phi": _w((lambda *s: torch.randn(*s, dtype=torch.bfloat16) * 0.2)(H, Dh, Dh) * (Dh ** -0.5)),
            "wo": _w((lambda *s: torch.randn(*s, dtype=torch.bfloat16) * 0.05)(D, D)),
        }
    _A_in = _A_setup()

    def _B_setup():
        B, S, D, F = 1, 2048, 512, 1376
        return {
            "x": _w((lambda *s: torch.randn(*s, dtype=torch.bfloat16) * 0.05)(B, S, D)),
            "w1": _w((lambda *s: torch.randn(*s, dtype=torch.bfloat16) * 0.8)(D, F) * (D ** -0.5)),
            "b1": _w((lambda *s: torch.randn(*s, dtype=torch.bfloat16) * 12.8)(F) * 0.01),
            "w2": _w((lambda *s: torch.randn(*s, dtype=torch.bfloat16) * 0.4)(F, D) * (F ** -0.5)),
            "b2": _w((lambda *s: torch.randn(*s, dtype=torch.bfloat16) * 6.4)(D) * 0.01),
        }
    _B_in = _B_setup()

    return {
        "A_x": _A_in["x"],
        "A_wqkv": _A_in["wqkv"],
        "A_w_phi": _A_in["w_phi"],
        "A_wo": _A_in["wo"],
        "B_x": _B_in["x"],
        "B_w1": _B_in["w1"],
        "B_b1": _B_in["b1"],
        "B_w2": _B_in["w2"],
        "B_b2": _B_in["b2"],
    }

def reference(A_x, A_wqkv, A_w_phi, A_wo, B_x, B_w1, B_b1, B_w2, B_b2):
    def _A_ref(x, wqkv, w_phi, wo):
        B, S, D = x.shape
        H = 32; Dh = D // H
        qkv = (lambda x, *d: x.permute(*d))((x @ wqkv).reshape(B, S, 3, H, Dh), 2, 0, 3, 1, 4)
        q, k, v = qkv[0], qkv[1], qkv[2]
        pq = torch.einsum("bhsd,hdf->bhsf", q, w_phi)
        pk = torch.einsum("bhsd,hdf->bhsf", k, w_phi)
        phi_q = torch.concatenate([_softmax(pq, axis=-1), _softmax(-pq, axis=-1)], axis=-1)
        phi_k = torch.concatenate([_softmax(pk, axis=-1), _softmax(-pk, axis=-1)], axis=-1)
        kv = torch.einsum("bhsf,bhsd->bhfd", phi_k, v)
        z  = torch.einsum("bhsf->bhf", phi_k)
        num = torch.einsum("bhqf,bhfd->bhqd", phi_q, kv)
        den = torch.einsum("bhqf,bhf->bhq", phi_q, z)[..., None] + 1e-6
        o = num / den
        return (lambda x, *d: x.permute(*d))(o, 0, 2, 1, 3).reshape(B, S, D) @ wo

    def _B_ref(x, w1, b1, w2, b2):
        h = torch.einsum("bsd,df->bsf", x, w1) + b1
        h = _gelu(h)
        return torch.einsum("bsf,fd->bsd", h, w2) + b2

    x = A_x
    xn = _layernorm(x, axis=-1)
    return x + _A_ref(xn, A_wqkv, A_w_phi, A_wo) + _B_ref(xn, B_w1, B_b1, B_w2, B_b2)
```

```asm
; @launch grid=(256,1,1) block=(512,1,1) lds=163840
.amdgcn_target "amdgcn-amd-amdhsa--gfx950"
.text
.globl parallel_sum__linear_kernel_hedgehog__dense_activation_gelu__prompt_kernel
.p2align 8
.type parallel_sum__linear_kernel_hedgehog__dense_activation_gelu__prompt_kernel,@function
parallel_sum__linear_kernel_hedgehog__dense_activation_gelu__prompt_kernel:
L_start:
    s_load_dwordx16 s[40:55], s[0:1], 0
    s_load_dwordx2 s[16:17], s[0:1], 88
    s_cmpk_ge_u32 s2, 0x100
    s_cbranch_scc1 L_end
    v_readfirstlane_b32 s66, v0
    v_and_b32 v0, 63, v0
    s_lshr_b32 s66, s66, 6
    s_getpc_b64 s[4:5]
    s_and_b32 s6, s2, 56
    s_add_u32 s6, s6, s66
    s_lshl_b32 s6, s6, 7
    v_lshl_add_u32 v1, v0, 13, s6
    s_mov_b64 exec, 15
    global_load_dword v216, v1, s[4:5]
    s_mov_b64 exec, -1
    s_cmp_ge_u32 s66, 4
    s_cbranch_scc1 L_C
    s_and_b32 s7, s2, 6
    s_lshr_b32 s65, s2, 6
    s_lshl1_add_u32 s60, s7, s65
    s_lshr_b32 s61, s2, 3
    s_add_u32 s70, s65, s61
    s_and_b32 s3, s70, 1
    s_or_b32 s3, s3, s7
    s_lshl2_add_u32 s3, s2, s3
    s_and_b32 s3, s3, 7
    s_lshl2_add_u32 s5, s60, s66
    s_lshl_b32 s5, s5, 8
    s_add_u32 s5, s5, s3
    s_lshl_b32 s5, s5, 7
    s_add_u32 s6, s5, 14336
    v_lshrrev_b32 v2, 3, v0
    v_lshrrev_b32 v4, 4, v0
    v_xor_b32 v4, v4, v0
    v_and_b32 v4, 7, v4
    v_lshlrev_b32 v4, 4, v4
    v_lshl_add_u32 v8, v2, 10, v4
    v_xor_b32 v9, 64, v8
    v_add_u32 v9, 7168, v9
    s_lshl_b32 s10, 1, 21
    s_mov_b32 s11, 0x20000
    s_lshl_b32 m0, s66, 12
    s_waitcnt lgkmcnt(0)
    s_mov_b64 s[8:9], s[40:41]
    buffer_load_dwordx4 v8, s[8:11], s5 offen offset:0  lds
    buffer_load_dwordx4 v9, s[8:11], s5 offen offset:1024  lds
    buffer_load_dwordx4 v8, s[8:11], s6 offen offset:2048  lds
    buffer_load_dwordx4 v9, s[8:11], s6 offen offset:3072  lds
L_entry_end:
    s_load_dwordx2 s[36:37], s[0:1], 64
    s_load_dwordx2 s[28:29], s[0:1], 72
    s_and_b32 s61, s61, 7
    s_and_b32 s64, s2, 1
    s_and_b32 s62, s61, 1
    s_and_b32 s67, s66, 3
    s_lshr_b32 s63, s61, 1
    s_lshl2_add_u32 s63, s64, s63
    s_add_u32 s6, s63, 1
    s_lshr_b32 s6, s6, 1
    s_min_u32 s6, s6, 3
    s_mul_i32 s77, s63, 5
    s_add_u32 s77, s77, s6
    s_lshr_b32 s78, 0x15, s63
    s_and_b32 s78, s78, 1
    s_lshl_b32 s73, s77, 6
    s_xor_b32 s6, s63, 1
    s_lshl_b32 s6, s6, 7
    s_movk_i32 s72, 2752
    s_movk_i32 s4, 128
    s_and_b32 s7, s63, 1
    s_lshl_b32 s7, s7, 8
    s_addk_i32 s7, 896
    s_cmp_eq_u32 s62, 0
    s_cselect_b32 s73, s6, s73
    s_cselect_b32 s72, 3072, s72
    s_cselect_b32 s7, s7, s4
    s_cselect_b32 s4, 1024, s4
    s_cselect_b32 s78, 1, s78
    s_cselect_b32 s12, s42, s50
    s_cselect_b32 s13, s43, s51
    s_mov_b32 s15, 0x20000
    s_lshl_b32 s14, s72, 9
    v_and_b32 v3, 7, v0
    v_and_b32 v4, 2, v2
    v_xor_b32 v4, v4, v3
    v_mul_u32_u24 v5, s72, v2
    s_lshl_b32 s5, s67, 4
    s_mul_i32 s1, s5, s72
    s_add_u32 s1, s1, s73
    s_lshl_b32 s77, s72, 6
    s_mul_i32 s6, s3, s77
    s_add_u32 s6, s6, s1
    s_lshl_b32 s71, s67, 11
    s_lshl_b32 s5, s72, 3
    s_sub_u32 s5, s5, 1024
    v_lshl_add_u32 v12, v4, 4, v5
    v_xor_b32 v3, 4, v4
    v_add_u32 v5, s5, v5
    v_lshl_add_u32 v13, v3, 4, v5
    s_add_u32 m0, s71, 16384
    v_add_u32_e64 v14, s7, v12
    buffer_load_dwordx4 v12, s[12:15], s6 offen offset:0  lds
    buffer_load_dwordx4 v13, s[12:15], s6 offen offset:1024  lds
    s_add_u32 m0, s71, 24576
    v_add_u32_e64 v15, s7, v13
    buffer_load_dwordx4 v14, s[12:15], s6 offen offset:0  lds
    buffer_load_dwordx4 v15, s[12:15], s6 offen offset:1024  lds
    s_cmp_eq_u32 s78, 1
    s_cselect_b32 s5, 8, 4
    v_mov_b32 v7, 0x7fff0000
    s_add_u32 m0, s71, 32768
    v_cmp_gt_u32 vcc, s5, v4
    v_add_u32 v6, s4, v14
    s_nop 0
    v_cndmask_b32 v16, v7, v6, vcc
    v_cmp_gt_u32 vcc, s5, v3
    v_add_u32 v6, s4, v15
    s_nop 0
    v_cndmask_b32 v17, v7, v6, vcc
    buffer_load_dwordx4 v16, s[12:15], s6 offen offset:0  lds
    buffer_load_dwordx4 v17, s[12:15], s6 offen offset:1024  lds
    v_add_u32 v10, 14336, v8
    v_add_u32 v11, 14336, v9
    s_lshl2_add_u32 s0, s60, s67
    s_lshl_b32 s0, s0, 15
    s_lshl_b32 s42, s67, 12
    s_mov_b32 s69, 0x76534210
    s_mov_b32 s7, 0x75643120
    s_bitcmp1_b32 s70, 0
    s_cselect_b32 s69, 0x67542301, s69
    s_cselect_b32 s7, 0x76453201, s7
    s_bitcmp1_b32 s70, 1
    s_cselect_b32 s69, s7, s69
    s_and_b32 s7, s3, 6
    s_mul_i32 s7, s7, 0x11111111
    s_add_u32 s69, s69, s7
    s_bfe_u32 s4, s70, 0x10001
    s_mov_b32 s34, 2752
    s_cmp_eq_u32 s62, 0
    s_cselect_b32 s32, s44, s52
    s_cselect_b32 s33, s45, s53
    s_cselect_b32 s34, 16384, s34
    s_and_b32 s33, s33, 0xffff
    s_mov_b32 s35, 0x20000
    s_mov_b32 s18, 268435456
    s_mov_b32 s19, 0x20000
    s_mov_b64 s[20:21], s[54:55]
    s_mov_b32 s22, 1409024
    s_mov_b32 s23, 0x20000
    s_mov_b64 s[24:25], s[46:47]
    s_mov_b32 s26, 524288
    s_mov_b32 s27, 0x20000
    s_mov_b32 s30, 2097152
    s_mov_b32 s31, 0x20000
    s_mov_b32 s38, 1024
    s_mov_b32 s39, 0x20000
    s_lshl_b32 s74, s60, 1
    s_add_u32 s74, s74, s64
    s_lshl_b32 s75, s64, 3
    s_add_u32 s75, s75, s61
    s_lshl_b32 s76, s62, 3
    s_add_u32 s76, s76, s63
    s_and_b32 s79, s65, 3
    s_mul_i32 s44, s67, 11
    s_cmp_eq_u32 s67, 3
    s_cselect_b32 s5, 5, 6
    s_add_u32 s45, s44, s5
    s_lshl_b32 s51, s61, 7
    s_xor_b32 s5, s79, 0
    s_and_b32 s6, s5, 1
    s_cmp_ge_u32 s5, 2
    s_cselect_b32 s5, s45, s44
    s_add_u32 s56, s5, s6
    s_xor_b32 s5, s79, 1
    s_and_b32 s6, s5, 1
    s_cmp_ge_u32 s5, 2
    s_cselect_b32 s5, s45, s44
    s_add_u32 s57, s5, s6
    s_xor_b32 s5, s79, 2
    s_and_b32 s6, s5, 1
    s_cmp_ge_u32 s5, 2
    s_cselect_b32 s5, s45, s44
    s_add_u32 s58, s5, s6
    s_xor_b32 s5, s79, 3
    s_and_b32 s6, s5, 1
    s_cmp_ge_u32 s5, 2
    s_cselect_b32 s5, s45, s44
    s_add_u32 s59, s5, s6
    s_lshl_b32 s5, s76, 2
    s_add_u32 s3, s5, s67
    s_lshl_b32 s40, s3, 12
    s_add_u32 s40, s40, 131072
    s_lshl_b32 s41, s60, 11
    s_lshl_b32 s5, s67, 9
    s_add_u32 s41, s41, s5
    s_add_u32 s41, s41, 65536
    s_xor_b32 s3, s3, 4
    s_lshl_b32 s43, s3, 11
    s_add_u32 s43, s43, 1179648
    s_lshl_b32 s50, s60, 13
    s_lshl_b32 s5, s3, 7
    s_add_u32 s50, s50, s5
    s_add_u32 s50, s50, 1572864
    s_lshl_b32 s46, s3, 14
    s_add_u32 s46, s46, 524288
    s_lshl_b32 s47, s3, 11
    s_add_u32 s47, s47, 1048576
    s_lshl_b32 s5, s60, 10
    s_add_u32 s53, s46, s5
    s_lshl_b32 s5, s60, 7
    s_add_u32 s54, s47, s5
    s_xor_b32 s53, s53, 65536
    s_xor_b32 s54, s54, 8192
    s_lshl_b32 s49, s74, 13
    s_lshl_b32 s5, s67, 9
    s_add_u32 s49, s49, s5
    s_add_u32 s49, s49, 1310720
    s_lshl_b32 s70, s74, 12
    s_lshl_b32 s5, s67, 10
    s_add_u32 s70, s70, s5
    s_add_u32 s70, s70, 1572864
    v_lshrrev_b32_e64 v2, 4, v0
    v_bfe_u32 v3, v0, 2, 2
    v_and_b32_e64 v4, 3, v0
    v_lshl_add_u32 v5, v2, 3, v3
    v_lshlrev_b32_e64 v5, 7, v5
    v_lshl_add_u32 v5, v4, 3, v5
    v_bfe_u32 v6, v0, 3, 2
    v_xor_b32_e64 v6, s67, v6
    v_lshl_add_u32 v5, v6, 5, v5
    s_lshl_b32 s5, s4, 12
    s_add_u32 s5, s5, 16384
    v_add_u32 v28, s5, v5
    v_mov_b32_e64 v19, 0
    buffer_load_dword v18, v19, s[16:19], 0 offen sc1
    s_bfe_u32 s3, s69, 0x30004
    s_lshl_b32 s5, s3, 7
    s_mul_i32 s6, s3, s77
    s_add_u32 s5, s5, s0
    s_add_u32 s6, s6, s1
    s_add_u32 m0, s42, 40960
    s_nop 0
    buffer_load_dwordx4 v8, s[8:11], s5 offen offset:0  lds
    s_add_u32 m0, s71, 57344
    s_nop 0
    buffer_load_dwordx4 v12, s[12:15], s6 offen offset:0  lds
    buffer_load_dwordx4 v13, s[12:15], s6 offen offset:1024  lds
    s_add_u32 m0, s42, 40960
    s_nop 0
    buffer_load_dwordx4 v9, s[8:11], s5 offen offset:1024  lds
    s_add_u32 m0, s71, 65536
    s_nop 0
    buffer_load_dwordx4 v14, s[12:15], s6 offen offset:0  lds
    buffer_load_dwordx4 v15, s[12:15], s6 offen offset:1024  lds
    s_add_u32 m0, s42, 40960
    s_nop 0
    buffer_load_dwordx4 v10, s[8:11], s5 offen offset:2048  lds
    s_waitcnt vmcnt(8)
    s_barrier
    ds_read_b64_tr_b16 v[32:33], v28 offset:0
    ds_read_b64_tr_b16 v[34:35], v28 offset:512
    ds_read_b64_tr_b16 v[36:37], v28 offset:8192
    ds_read_b64_tr_b16 v[38:39], v28 offset:8704
    ds_read_b64_tr_b16 v[40:41], v28 offset:16384
    ds_read_b64_tr_b16 v[42:43], v28 offset:16896
    s_bfe_u32 s3, s69, 0x30004
    s_lshl_b32 s5, s3, 7
    s_mul_i32 s6, s3, s77
    s_add_u32 s5, s5, s0
    s_add_u32 s6, s6, s1
    s_add_u32 m0, s71, 73728
    s_nop 0
    buffer_load_dwordx4 v16, s[12:15], s6 offen offset:0  lds
    buffer_load_dwordx4 v17, s[12:15], s6 offen offset:1024  lds
    s_add_u32 m0, s42, 40960
    s_nop 0
    buffer_load_dwordx4 v11, s[8:11], s5 offen offset:3072  lds
    s_bfe_u32 s3, s69, 0x30008
    s_lshl_b32 s5, s3, 7
    s_mul_i32 s6, s3, s77
    s_add_u32 s5, s5, s0
    s_add_u32 s6, s6, s1
    s_add_u32 m0, s42, 81920
    s_nop 0
    buffer_load_dwordx4 v8, s[8:11], s5 offen offset:0  lds
    s_add_u32 m0, s71, 98304
    s_nop 0
    buffer_load_dwordx4 v12, s[12:15], s6 offen offset:0  lds
    buffer_load_dwordx4 v13, s[12:15], s6 offen offset:1024  lds
    s_add_u32 m0, s42, 81920
    s_nop 0
    buffer_load_dwordx4 v9, s[8:11], s5 offen offset:1024  lds
    s_add_u32 m0, s71, 106496
    s_nop 0
    buffer_load_dwordx4 v14, s[12:15], s6 offen offset:0  lds
    buffer_load_dwordx4 v15, s[12:15], s6 offen offset:1024  lds
    s_add_u32 m0, s42, 81920
    s_nop 0
    buffer_load_dwordx4 v10, s[8:11], s5 offen offset:2048  lds
    s_cmp_eq_u32 s62, 0
    s_cbranch_scc1 L_H0
L_H1:
    s_waitcnt lgkmcnt(0)
    s_waitcnt vmcnt(7)
    s_barrier
    s_bfe_u32 s3, s69, 0x30008
    s_lshl_b32 s5, s3, 7
    s_mul_i32 s6, s3, s77
    s_add_u32 s5, s5, s0
    s_add_u32 s6, s6, s1
    s_add_u32 m0, s71, 114688
    s_nop 0
    buffer_load_dwordx4 v16, s[12:15], s6 offen offset:0  lds
    buffer_load_dwordx4 v17, s[12:15], s6 offen offset:1024  lds
    s_add_u32 m0, s42, 81920
    s_nop 0
    buffer_load_dwordx4 v11, s[8:11], s5 offen offset:3072  lds
    s_setprio 3
    v_mov_b32 v24, 0x3f803f80
    v_mov_b32 v25, 0x3f803f80
    v_mov_b32 v26, 0x3f803f80
    v_mov_b32 v27, 0x3f803f80
    v_lshlrev_b32 v251, 4, v0
    s_nop 0
    v_mfma_f32_16x16x32_bf16 v[48:51], v[24:27], v[32:35], 0
    v_mfma_f32_16x16x32_bf16 v[52:55], v[24:27], v[36:39], 0
    v_mfma_f32_16x16x32_bf16 v[56:59], v[24:27], v[40:43], 0
    v_readfirstlane_b32 s68, v18
    s_nop 0
    s_mul_i32 s68, s68, 0x9E3779B1
    s_add_u32 s68, s68, 0x7F4A7C15
    s_lshl_b32 s5, s60, 8
    s_add_u32 s7, s5, s40
    v_mov_b32 v1, s68
    v_mov_b32 v63, 0
    v_mov_b32 v49, v52
    v_mov_b32 v50, v56
    v_mov_b32 v51, s68
    s_lshl2_add_u32 s52, s2, s67
    s_lshr_b32 s5, s2, 3
    s_lshl2_add_u32 s55, s5, s67
    s_mov_b64 exec, 0xffff
    buffer_store_dwordx4 v[48:51], v251, s[16:19], s7 offen sc1
    s_mov_b64 exec, -1
    s_bfe_u32 s3, s69, 0x3000c
    s_lshl_b32 s5, s3, 7
    s_mul_i32 s6, s3, s77
    s_add_u32 s5, s5, s0
    s_add_u32 s6, s6, s1
    s_add_u32 m0, s42, 0
    s_nop 0
    buffer_load_dwordx4 v8, s[8:11], s5 offen offset:0  lds
    s_add_u32 m0, s71, 16384
    s_nop 0
    buffer_load_dwordx4 v12, s[12:15], s6 offen offset:0  lds
    buffer_load_dwordx4 v13, s[12:15], s6 offen offset:1024  lds
    s_add_u32 m0, s42, 0
    s_nop 0
    buffer_load_dwordx4 v9, s[8:11], s5 offen offset:1024  lds
    s_add_u32 m0, s71, 24576
    s_nop 0
    buffer_load_dwordx4 v14, s[12:15], s6 offen offset:0  lds
    buffer_load_dwordx4 v15, s[12:15], s6 offen offset:1024  lds
    s_add_u32 m0, s42, 0
    s_nop 0
    buffer_load_dwordx4 v10, s[8:11], s5 offen offset:2048  lds
    s_add_u32 m0, s71, 32768
    s_nop 0
    buffer_load_dwordx4 v16, s[12:15], s6 offen offset:0  lds
    buffer_load_dwordx4 v17, s[12:15], s6 offen offset:1024  lds
    s_add_u32 m0, s42, 0
    s_nop 0
    buffer_load_dwordx4 v11, s[8:11], s5 offen offset:3072  lds
    v_and_b32 v29, 31, v0
    v_lshrrev_b32 v30, 5, v0
    v_lshlrev_b32 v29, 4, v29
    v_lshrrev_b32 v2, 4, v0
    v_and_b32 v3, 15, v0
    v_lshlrev_b32 v4, 4, v3
    v_lshl_add_u32 v78, v2, 10, v4
    s_lshl_b32 s5, s67, 8
    s_add_u32 s6, s5, 147456
    v_add_u32 v31, s6, v78
    s_add_u32 s6, s5, 153600
    v_lshrrev_b32 v5, 1, v29
    v_add_u32_e64 v77, s6, v5
    s_lshl_b32 s5, s67, 9
    s_add_u32 s5, s5, 151552
    v_add_u32 v76, s5, v29
    v_lshlrev_b32 v3, 1, v3
    v_lshl_add_u32 v79, v2, 7, v3
    v_lshrrev_b32 v2, 3, v0
    v_and_b32 v3, 7, v0
    v_and_b32 v4, 2, v2
    v_xor_b32 v3, v3, v4
    v_lshlrev_b32 v3, 4, v3
    v_lshrrev_b32 v4, 2, v2
    v_and_b32_e64 v5, 3, v2
    v_lshl_add_u32 v4, v4, 4, v5
    v_lshl_add_u32 v20, v4, 10, v3
    v_xor_b32_e64 v21, 64, v20
    v_add_u32 v21, 3072, v21
    v_add_u32 v22, 6144, v20
    v_xor_b32_e64 v23, 64, v20
    v_add_u32 v23, 9216, v23
    v_lshrrev_b32 v2, 3, v0
    v_and_b32 v3, 7, v0
    v_lshlrev_b32_e64 v249, 4, v3
    v_lshl_add_u32 v248, v2, 10, v249
    s_lshl_b32 s5, s74, 16
    s_lshl_b32 s6, s66, 13
    s_add_u32 s5, s5, s6
    s_add_u32 s5, s5, s51
    v_add_u32 v248, s5, v248
    s_lshr_b32 s5, s66, 1
    s_lshl_b32 s5, s5, 15
    s_and_b32 s6, s66, 1
    s_lshl_b32 s6, s6, 7
    s_add_u32 s5, s5, s6
    v_lshrrev_b32_e64 v2, 5, v0
    v_lshl_add_u32 v255, v2, 6, s5
    v_bfe_u32 v2, v0, 0, 1
    v_mul_u32_u24 v2, 32, v2
    v_add_u32 v255, v255, v2
    v_bfe_u32 v2, v0, 1, 1
    v_mul_u32_u24 v2, 272, v2
    v_add_u32_e64 v255, v255, v2
    v_bfe_u32 v2, v0, 2, 1
    v_mul_u32_u24 v2, 768, v2
    v_add_u32_e64 v255, v255, v2
    v_bfe_u32 v2, v0, 3, 1
    v_mul_u32_u24 v2, 1344, v2
    v_add_u32_e64 v255, v255, v2
    v_bfe_u32 v2, v0, 4, 1
    v_mul_u32_u24 v2, 16512, v2
    v_add_u32 v255, v255, v2
    v_lshlrev_b32 v232, 7, v0
    s_mul_i32 s6, s52, 1408
    s_min_u32 s6, s6, 1407616
    s_add_u32 s6, s6, 60
    s_add_u32 s6, s20, s6
    s_addc_u32 s7, s21, 0
    s_load_dwordx2 vcc, s[6:7], 0
    s_load_dwordx2 vcc, s[6:7], 128
    s_load_dwordx2 vcc, s[6:7], 256
    s_load_dwordx2 vcc, s[6:7], 384
    s_waitcnt vmcnt(11)
    s_barrier
    s_bfe_u32 s3, s69, 0x30010
    s_lshl_b32 s5, s3, 7
    s_mul_i32 s6, s3, s77
    s_add_u32 s5, s5, s0
    s_add_u32 s6, s6, s1
    s_add_u32 m0, s42, 40960
    s_nop 0
    buffer_load_dwordx4 v8, s[8:11], s5 offen offset:0  lds
    s_add_u32 m0, s71, 57344
    s_nop 0
    buffer_load_dwordx4 v12, s[12:15], s6 offen offset:0  lds
    buffer_load_dwordx4 v13, s[12:15], s6 offen offset:1024  lds
    s_add_u32 m0, s42, 40960
    s_nop 0
    buffer_load_dwordx4 v9, s[8:11], s5 offen offset:1024  lds
    s_add_u32 m0, s71, 65536
    s_nop 0
    buffer_load_dwordx4 v14, s[12:15], s6 offen offset:0  lds
    buffer_load_dwordx4 v15, s[12:15], s6 offen offset:1024  lds
    s_add_u32 m0, s42, 40960
    s_nop 0
    buffer_load_dwordx4 v10, s[8:11], s5 offen offset:2048  lds
    s_add_u32 m0, s71, 73728
    s_nop 0
    buffer_load_dwordx4 v16, s[12:15], s6 offen offset:0  lds
    buffer_load_dwordx4 v17, s[12:15], s6 offen offset:1024  lds
    s_add_u32 m0, s42, 40960
    s_nop 0
    buffer_load_dwordx4 v11, s[8:11], s5 offen offset:3072  lds
    s_lshl_b32 s5, s67, 5
    s_add_u32 s5, s5, s73
    buffer_load_ushort v19, v79, s[32:35], s5 offen
    s_mul_i32 s6, s52, 1408
    s_min_u32 s6, s6, 1407616
    s_add_u32 s6, s6, 60
    s_add_u32 s6, s20, s6
    s_addc_u32 s7, s21, 0
    s_load_dwordx2 vcc, s[6:7], 512
    s_load_dwordx2 vcc, s[6:7], 640
    s_load_dwordx2 vcc, s[6:7], 768
    s_load_dwordx2 vcc, s[6:7], 896
    s_waitcnt vmcnt(11)
    s_barrier
    s_bfe_u32 s3, s69, 0x30014
    s_lshl_b32 s5, s3, 7
    s_mul_i32 s6, s3, s77
    s_add_u32 s5, s5, s0
    s_add_u32 s6, s6, s1
    s_add_u32 m0, s42, 81920
    s_nop 0
    buffer_load_dwordx4 v8, s[8:11], s5 offen offset:0  lds
    s_add_u32 m0, s71, 98304
    s_nop 0
    buffer_load_dwordx4 v12, s[12:15], s6 offen offset:0  lds
    buffer_load_dwordx4 v13, s[12:15], s6 offen offset:1024  lds
    s_add_u32 m0, s42, 81920
    s_nop 0
    buffer_load_dwordx4 v9, s[8:11], s5 offen offset:1024  lds
    s_add_u32 m0, s71, 106496
    s_nop 0
    buffer_load_dwordx4 v14, s[12:15], s6 offen offset:0  lds
    buffer_load_dwordx4 v15, s[12:15], s6 offen offset:1024  lds
    s_add_u32 m0, s42, 81920
    s_nop 0
    buffer_load_dwordx4 v10, s[8:11], s5 offen offset:2048  lds
    s_add_u32 m0, s71, 114688
    s_nop 0
    buffer_load_dwordx4 v16, s[12:15], s6 offen offset:0  lds
    buffer_load_dwordx4 v17, s[12:15], s6 offen offset:1024  lds
    s_add_u32 m0, s42, 81920
    s_nop 0
    buffer_load_dwordx4 v11, s[8:11], s5 offen offset:3072  lds
    s_mul_i32 s6, s52, 1408
    s_min_u32 s6, s6, 1407616
    s_add_u32 s6, s6, 60
    s_add_u32 s6, s20, s6
    s_addc_u32 s7, s21, 0
    s_load_dwordx2 vcc, s[6:7], 1024
    s_load_dwordx2 vcc, s[6:7], 1152
    s_load_dwordx2 vcc, s[6:7], 1280
    s_mul_i32 s6, s52, 512
    s_min_u32 s6, s6, 523776
    s_add_u32 s6, s6, 60
    s_add_u32 s6, s24, s6
    s_addc_u32 s7, s25, 0
    s_load_dwordx2 vcc, s[6:7], 0
    s_waitcnt vmcnt(11)
    s_barrier
    s_bfe_u32 s3, s69, 0x30018
    s_lshl_b32 s5, s3, 7
    s_mul_i32 s6, s3, s77
    s_add_u32 s5, s5, s0
    s_add_u32 s6, s6, s1
    s_add_u32 m0, s42, 0
    s_nop 0
    buffer_load_dwordx4 v8, s[8:11], s5 offen offset:0  lds
    s_add_u32 m0, s71, 16384
    s_nop 0
    buffer_load_dwordx4 v12, s[12:15], s6 offen offset:0  lds
    buffer_load_dwordx4 v13, s[12:15], s6 offen offset:1024  lds
    s_add_u32 m0, s42, 0
    s_nop 0
    buffer_load_dwordx4 v9, s[8:11], s5 offen offset:1024  lds
    s_add_u32 m0, s71, 24576
    s_nop 0
    buffer_load_dwordx4 v14, s[12:15], s6 offen offset:0  lds
    buffer_load_dwordx4 v15, s[12:15], s6 offen offset:1024  lds
    s_add_u32 m0, s42, 0
    s_nop 0
    buffer_load_dwordx4 v10, s[8:11], s5 offen offset:2048  lds
    s_add_u32 m0, s71, 32768
    s_nop 0
    buffer_load_dwordx4 v16, s[12:15], s6 offen offset:0  lds
    buffer_load_dwordx4 v17, s[12:15], s6 offen offset:1024  lds
    s_add_u32 m0, s42, 0
    s_nop 0
    buffer_load_dwordx4 v11, s[8:11], s5 offen offset:3072  lds
    s_mul_i32 s6, s52, 512
    s_min_u32 s6, s6, 523776
    s_add_u32 s6, s6, 60
    s_add_u32 s6, s24, s6
    s_addc_u32 s7, s25, 0
    s_load_dwordx2 vcc, s[6:7], 128
    s_load_dwordx2 vcc, s[6:7], 256
    s_load_dwordx2 vcc, s[6:7], 384
    s_waitcnt vmcnt(10)
    s_barrier
    s_bfe_u32 s3, s69, 0x3001c
    s_lshl_b32 s5, s3, 7
    s_mul_i32 s6, s3, s77
    s_add_u32 s5, s5, s0
    s_add_u32 s6, s6, s1
    s_add_u32 m0, s42, 40960
    s_nop 0
    buffer_load_dwordx4 v8, s[8:11], s5 offen offset:0  lds
    s_add_u32 m0, s71, 57344
    s_nop 0
    buffer_load_dwordx4 v12, s[12:15], s6 offen offset:0  lds
    buffer_load_dwordx4 v13, s[12:15], s6 offen offset:1024  lds
    s_add_u32 m0, s42, 40960
    s_nop 0
    buffer_load_dwordx4 v9, s[8:11], s5 offen offset:1024  lds
    s_add_u32 m0, s71, 65536
    s_nop 0
    buffer_load_dwordx4 v14, s[12:15], s6 offen offset:0  lds
    buffer_load_dwordx4 v15, s[12:15], s6 offen offset:1024  lds
    s_add_u32 m0, s42, 40960
    s_nop 0
    buffer_load_dwordx4 v10, s[8:11], s5 offen offset:2048  lds
    s_add_u32 m0, s71, 73728
    s_nop 0
    buffer_load_dwordx4 v16, s[12:15], s6 offen offset:0  lds
    buffer_load_dwordx4 v17, s[12:15], s6 offen offset:1024  lds
    s_add_u32 m0, s42, 40960
    s_nop 0
    buffer_load_dwordx4 v11, s[8:11], s5 offen offset:3072  lds
    v_lshl_or_b32 v61, v19, 16, v19
    s_waitcnt vmcnt(10)
    s_barrier
    buffer_load_dwordx4 v[32:35], v251, s[16:19], s40 offen offset:0 sc1
    buffer_load_dwordx4 v[36:39], v251, s[16:19], s40 offen offset:1024 sc1
    buffer_load_dwordx4 v[40:43], v251, s[16:19], s40 offen offset:2048 sc1
    buffer_load_dwordx4 v[44:47], v251, s[16:19], s40 offen offset:3072 sc1
    buffer_load_dwordx4 v[48:51], v29, s[16:19], s41 offen sc1
    s_add_u32 m0, s42, 131072
    s_add_u32 s6, s56, 0
    s_lshl_b32 s6, s6, 15
    s_add_u32 s6, s6, s51
    buffer_load_dwordx4 v20, s[20:23], s6 offen offset:0 lds
    buffer_load_dwordx4 v21, s[20:23], s6 offen offset:1024 lds
    buffer_load_dwordx4 v22, s[20:23], s6 offen offset:2048 lds
    buffer_load_dwordx4 v23, s[20:23], s6 offen offset:3072 lds
    s_waitcnt vmcnt(9)
    s_barrier
    s_add_u32 m0, s42, 81920
    s_add_u32 s6, s57, 0
    s_lshl_b32 s6, s6, 15
    s_add_u32 s6, s6, s51
    buffer_load_dwordx4 v20, s[20:23], s6 offen offset:0 lds
    buffer_load_dwordx4 v21, s[20:23], s6 offen offset:1024 lds
    buffer_load_dwordx4 v22, s[20:23], s6 offen offset:2048 lds
    buffer_load_dwordx4 v23, s[20:23], s6 offen offset:3072 lds
    s_waitcnt vmcnt(8)
    s_waitcnt lgkmcnt(0)
    s_mov_b32 s3, 0
L_Hchk1:
    v_cmp_ne_u32 vcc, s68, v35
    v_cmp_ne_u32 s[0:1], s68, v39
    v_cmp_ne_u32 s[4:5], s68, v43
    v_cmp_ne_u32 s[6:7], s68, v47
    s_or_b64 s[0:1], s[0:1], vcc
    v_cmp_ne_u32 vcc, s68, v51
    s_or_b64 s[4:5], s[4:5], s[6:7]
    s_or_b64 s[0:1], s[0:1], s[4:5]
    s_or_b64 s[0:1], s[0:1], vcc
    s_cbranch_scc0 L_Hok1
    s_add_u32 s3, s3, 1
    s_cmp_gt_u32 s3, 200000
    s_cbranch_scc1 L_Hok1
    buffer_load_dwordx4 v[32:35], v251, s[16:19], s40 offen offset:0 sc1
    buffer_load_dwordx4 v[36:39], v251, s[16:19], s40 offen offset:1024 sc1
    buffer_load_dwordx4 v[40:43], v251, s[16:19], s40 offen offset:2048 sc1
    buffer_load_dwordx4 v[44:47], v251, s[16:19], s40 offen offset:3072 sc1
    buffer_load_dwordx4 v[48:51], v29, s[16:19], s41 offen sc1
    s_waitcnt vmcnt(0)
    s_branch L_Hchk1
L_Hok1:
    v_add_f32 v32, v32, v36
    v_add_f32 v40, v40, v44
    v_add_f32 v33, v33, v37
    v_add_f32 v41, v41, v45
    v_add_f32 v34, v34, v38
    v_add_f32 v42, v42, v46
    v_mov_b32 v35, 0
    v_add_f32 v32, v32, v40
    v_add_f32 v34, v34, v42
    v_add_f32 v33, v33, v41
    v_lshlrev_b32 v52, 16, v49
    v_and_b32 v53, 0xffff0000, v49
    v_permlane32_swap_b32 v32, v34
    v_permlane32_swap_b32 v33, v35
    v_add_f32 v32, v32, v34
    v_add_f32 v33, v33, v35
    v_add_f32_e64 v52, v52, v53
    ds_write2_b32 v77, v52, v50 offset0:0 offset1:1
    v_mov_b32 v50, v48
    v_mov_b32 v51, 0
    v_permlane16_swap_b32 v32, v33
    v_add_f32 v32, v32, v33
    ds_write_b128 v76, v[48:51]
    v_cvt_pk_bf16_f32 v60, v32, v32
    v_lshlrev_b32 v34, 16, v60
    v_sub_f32 v34, v32, v34
    v_cvt_pk_bf16_f32 v62, v34, v34
    s_mov_b32 exec_lo, 0
    s_mov_b32 exec_hi, 0xffff0000
    v_mov_b32_e64 v61, 0
    s_mov_b64 exec, -1
    ds_write_b128 v31, v[60:63]
    s_add_u32 m0, s42, 98304
    s_add_u32 s6, s58, 0
    s_lshl_b32 s6, s6, 15
    s_add_u32 s6, s6, s51
    buffer_load_dwordx4 v20, s[20:23], s6 offen offset:0 lds
    buffer_load_dwordx4 v21, s[20:23], s6 offen offset:1024 lds
    buffer_load_dwordx4 v22, s[20:23], s6 offen offset:2048 lds
    buffer_load_dwordx4 v23, s[20:23], s6 offen offset:3072 lds
    s_waitcnt lgkmcnt(0)
    s_barrier
    s_setprio 0
    buffer_load_dwordx4 v[240:243], v248, s[8:11], 0 offen
    buffer_load_dwordx4 v[244:247], v249, s[36:39], s51 offen
    s_add_u32 m0, s42, 114688
    s_add_u32 s6, s59, 0
    s_lshl_b32 s6, s6, 15
    s_add_u32 s6, s6, s51
    s_waitcnt vmcnt(2)
    buffer_load_dwordx4 v20, s[20:23], s6 offen offset:0 lds
    s_waitcnt vmcnt(2)
    buffer_load_dwordx4 v21, s[20:23], s6 offen offset:1024 lds
    s_waitcnt vmcnt(2)
    buffer_load_dwordx4 v22, s[20:23], s6 offen offset:2048 lds
    s_waitcnt vmcnt(2)
    buffer_load_dwordx4 v23, s[20:23], s6 offen offset:3072 lds
    s_add_u32 m0, s42, 0
    s_add_u32 s6, s56, 2
    s_lshl_b32 s6, s6, 15
    s_add_u32 s6, s6, s51
    s_waitcnt vmcnt(2)
    buffer_load_dwordx4 v20, s[20:23], s6 offen offset:0 lds
    s_waitcnt vmcnt(2)
    buffer_load_dwordx4 v21, s[20:23], s6 offen offset:1024 lds
    s_waitcnt vmcnt(2)
    buffer_load_dwordx4 v22, s[20:23], s6 offen offset:2048 lds
    s_waitcnt vmcnt(2)
    buffer_load_dwordx4 v23, s[20:23], s6 offen offset:3072 lds
    s_add_u32 m0, s42, 16384
    s_add_u32 s6, s57, 2
    s_lshl_b32 s6, s6, 15
    s_add_u32 s6, s6, s51
    s_waitcnt vmcnt(2)
    buffer_load_dwordx4 v20, s[20:23], s6 offen offset:0 lds
    s_waitcnt vmcnt(2)
    buffer_load_dwordx4 v21, s[20:23], s6 offen offset:1024 lds
    s_waitcnt vmcnt(2)
    buffer_load_dwordx4 v22, s[20:23], s6 offen offset:2048 lds
    s_waitcnt vmcnt(2)
    buffer_load_dwordx4 v23, s[20:23], s6 offen offset:3072 lds
    s_add_u32 m0, s42, 32768
    s_add_u32 s6, s58, 2
    s_lshl_b32 s6, s6, 15
    s_add_u32 s6, s6, s51
    s_waitcnt vmcnt(2)
    buffer_load_dwordx4 v20, s[20:23], s6 offen offset:0 lds
    s_waitcnt vmcnt(2)
    buffer_load_dwordx4 v21, s[20:23], s6 offen offset:1024 lds
    s_waitcnt vmcnt(2)
    buffer_load_dwordx4 v22, s[20:23], s6 offen offset:2048 lds
    s_waitcnt vmcnt(2)
    buffer_load_dwordx4 v23, s[20:23], s6 offen offset:3072 lds
    s_add_u32 m0, s42, 49152
    s_add_u32 s6, s59, 2
    s_lshl_b32 s6, s6, 15
    s_add_u32 s6, s6, s51
    s_waitcnt vmcnt(2)
    buffer_load_dwordx4 v20, s[20:23], s6 offen offset:0 lds
    s_waitcnt vmcnt(2)
    buffer_load_dwordx4 v21, s[20:23], s6 offen offset:1024 lds
    s_waitcnt vmcnt(2)
    buffer_load_dwordx4 v22, s[20:23], s6 offen offset:2048 lds
    s_waitcnt vmcnt(2)
    buffer_load_dwordx4 v23, s[20:23], s6 offen offset:3072 lds
    s_barrier
    s_setprio 3
    s_add_u32 s4, s49, 0
    s_mov_b64 exec, 0xf
    s_mov_b32 s7, 0
L_poll_1:
    buffer_load_dword v235, v232, s[16:19], s4 offen offset:0 sc1
    s_add_u32 s7, s7, 1
    s_cmp_gt_u32 s7, 200000
    s_cbranch_scc1 L_polld_2
    s_waitcnt vmcnt(0)
    v_cmp_ne_u32 vcc, s68, v235
    s_nop 0
    s_cbranch_vccz L_polld_2
    s_sleep 6
    s_branch L_poll_1
L_polld_2:
    s_waitcnt vmcnt(0)
    s_mov_b64 exec, -1
L_rdy7:
    s_barrier
    s_setprio 3
L_fill8:
    s_add_u32 s4, s49, 2048
    s_mov_b64 exec, 0xf
    s_mov_b32 s7, 0
L_poll_3:
    buffer_load_dword v235, v232, s[16:19], s4 offen offset:0 sc1
    s_add_u32 s7, s7, 1
    s_cmp_gt_u32 s7, 200000
    s_cbranch_scc1 L_polld_4
    s_waitcnt vmcnt(0)
    v_cmp_ne_u32 vcc, s68, v235
    s_nop 0
    s_cbranch_vccz L_polld_4
    s_sleep 6
    s_branch L_poll_3
L_polld_4:
    s_waitcnt vmcnt(0)
    s_mov_b64 exec, -1
    s_barrier
    s_add_u32 s4, s49, 4096
    s_mov_b64 exec, 0xf
    s_mov_b32 s7, 0
L_poll_5:
    buffer_load_dword v235, v232, s[16:19], s4 offen offset:0 sc1
    s_add_u32 s7, s7, 1
    s_cmp_gt_u32 s7, 200000
    s_cbranch_scc1 L_polld_6
    s_waitcnt vmcnt(0)
    v_cmp_ne_u32 vcc, s68, v235
    s_nop 0
    s_cbranch_vccz L_polld_6
    s_sleep 6
    s_branch L_poll_5
L_polld_6:
    s_waitcnt vmcnt(0)
    s_mov_b64 exec, -1
    s_barrier
    s_branch L_Hfin
L_H0:
    s_waitcnt lgkmcnt(0)
    s_waitcnt vmcnt(7)
    s_barrier
    s_bfe_u32 s3, s69, 0x30008
    s_lshl_b32 s5, s3, 7
    s_mul_i32 s6, s3, s77
    s_add_u32 s5, s5, s0
    s_add_u32 s6, s6, s1
    s_add_u32 m0, s71, 114688
    s_nop 0
    buffer_load_dwordx4 v16, s[12:15], s6 offen offset:0  lds
    buffer_load_dwordx4 v17, s[12:15], s6 offen offset:1024  lds
    s_add_u32 m0, s42, 81920
    s_nop 0
    buffer_load_dwordx4 v11, s[8:11], s5 offen offset:3072  lds
    s_setprio 3
    v_mov_b32 v24, 0x3f803f80
    v_mov_b32 v25, 0x3f803f80
    v_mov_b32 v26, 0x3f803f80
    v_mov_b32 v27, 0x3f803f80
    v_lshlrev_b32 v251, 4, v0
    s_nop 0
    v_mfma_f32_16x16x32_bf16 v[48:51], v[24:27], v[32:35], 0
    v_mfma_f32_16x16x32_bf16 v[52:55], v[24:27], v[36:39], 0
    v_mfma_f32_16x16x32_bf16 v[56:59], v[24:27], v[40:43], 0
    v_readfirstlane_b32 s68, v18
    s_nop 0
    s_mul_i32 s68, s68, 0x9E3779B1
    s_add_u32 s68, s68, 0x7F4A7C15
    s_lshl_b32 s5, s60, 8
    s_add_u32 s7, s5, s40
    v_mov_b32 v1, s68
    v_mov_b32 v63, 0
    v_mov_b32 v49, v52
    v_mov_b32 v50, v56
    v_mov_b32 v51, s68
    s_lshl2_add_u32 s52, s2, s67
    s_lshr_b32 s5, s2, 3
    s_lshl2_add_u32 s55, s5, s67
    s_mov_b64 exec, 0xffff
    buffer_store_dwordx4 v[48:51], v251, s[16:19], s7 offen sc1
    s_mov_b64 exec, -1
    s_bfe_u32 s3, s69, 0x3000c
    s_lshl_b32 s5, s3, 7
    s_mul_i32 s6, s3, s77
    s_add_u32 s5, s5, s0
    s_add_u32 s6, s6, s1
    s_add_u32 m0, s42, 0
    s_nop 0
    buffer_load_dwordx4 v8, s[8:11], s5 offen offset:0  lds
    s_add_u32 m0, s71, 16384
    s_nop 0
    buffer_load_dwordx4 v12, s[12:15], s6 offen offset:0  lds
    buffer_load_dwordx4 v13, s[12:15], s6 offen offset:1024  lds
    s_add_u32 m0, s42, 0
    s_nop 0
    buffer_load_dwordx4 v9, s[8:11], s5 offen offset:1024  lds
    s_add_u32 m0, s71, 24576
    s_nop 0
    buffer_load_dwordx4 v14, s[12:15], s6 offen offset:0  lds
    buffer_load_dwordx4 v15, s[12:15], s6 offen offset:1024  lds
    s_add_u32 m0, s42, 0
    s_nop 0
    buffer_load_dwordx4 v10, s[8:11], s5 offen offset:2048  lds
    s_add_u32 m0, s71, 32768
    s_nop 0
    buffer_load_dwordx4 v16, s[12:15], s6 offen offset:0  lds
    buffer_load_dwordx4 v17, s[12:15], s6 offen offset:1024  lds
    s_add_u32 m0, s42, 0
    s_nop 0
    buffer_load_dwordx4 v11, s[8:11], s5 offen offset:3072  lds
    v_and_b32 v29, 31, v0
    v_lshrrev_b32 v30, 5, v0
    v_lshlrev_b32 v29, 4, v29
    v_lshrrev_b32 v2, 4, v0
    v_and_b32 v3, 15, v0
    v_lshlrev_b32 v4, 4, v3
    v_lshl_add_u32 v78, v2, 10, v4
    s_lshl_b32 s5, s67, 8
    s_add_u32 s6, s5, 147456
    v_add_u32 v31, s6, v78
    s_add_u32 s6, s5, 153600
    v_lshrrev_b32 v5, 1, v29
    v_add_u32_e64 v77, s6, v5
    s_lshl_b32 s5, s67, 9
    s_add_u32 s5, s5, 151552
    v_add_u32_e64 v76, s5, v29
    v_lshl_add_u32 v4, v30, 8, v4
    v_and_b32_e64 v5, 1, v2
    v_lshl_add_u32 v233, v5, 10, v4
    v_and_b32_e64 v4, 1, v0
    v_lshl_add_u32 v4, v2, 1, v4
    v_lshlrev_b32 v253, 4, v4
    v_lshrrev_b32 v5, 1, v3
    v_lshl_add_u32 v254, v5, 7, v253
    v_mov_b64 v[72:73], -1
    v_mov_b64 v[74:75], -1
    v_lshlrev_b32 v236, 2, v0
    v_lshrrev_b32 v2, 3, v0
    v_and_b32 v3, 7, v0
    v_and_b32 v4, 2, v2
    v_xor_b32 v3, v3, v4
    v_lshlrev_b32 v3, 4, v3
    v_lshrrev_b32 v4, 2, v2
    v_and_b32 v5, 3, v2
    v_lshl_add_u32 v4, v4, 4, v5
    v_lshl_add_u32 v20, v4, 10, v3
    v_xor_b32_e64 v21, 64, v20
    v_add_u32 v21, 3072, v21
    v_add_u32 v22, 6144, v20
    v_xor_b32_e64 v23, 64, v20
    v_add_u32 v23, 9216, v23
    v_lshrrev_b32_e64 v3, 5, v0
    v_bfe_u32 v4, v0, 2, 2
    v_lshl_add_u32 v3, v3, 3, v4
    v_lshlrev_b32_e64 v234, 5, v3
    v_bfe_u32 v3, v0, 4, 1
    v_bfe_u32 v4, v0, 1, 1
    v_lshl_add_u32 v3, v3, 1, v4
    v_lshl_add_u32 v234, v3, 3, v234
    s_lshl_b32 s5, s67, 9
    s_and_b32 s6, s63, 1
    s_xor_b32 s6, s6, 1
    s_lshl_b32 s6, s6, 11
    s_add_u32 s5, s5, s6
    s_add_u32 s5, s5, 154624
    v_add_u32 v234, s5, v234
    v_lshlrev_b32_e64 v3, 3, v0
    v_add_u32 v237, 153600, v3
    v_lshrrev_b32 v2, 3, v0
    v_and_b32 v3, 7, v0
    v_lshlrev_b32_e64 v249, 4, v3
    v_lshl_add_u32 v248, v2, 10, v249
    s_lshl_b32 s5, s74, 16
    s_lshl_b32 s6, s66, 13
    s_add_u32 s5, s5, s6
    s_add_u32 s5, s5, s51
    v_add_u32 v248, s5, v248
    s_lshr_b32 s5, s66, 1
    s_lshl_b32 s5, s5, 15
    s_and_b32 s6, s66, 1
    s_lshl_b32 s6, s6, 7
    s_add_u32 s5, s5, s6
    v_lshrrev_b32_e64 v2, 5, v0
    v_lshl_add_u32 v255, v2, 6, s5
    v_bfe_u32 v2, v0, 0, 1
    v_mul_u32_u24 v2, 32, v2
    v_add_u32 v255, v255, v2
    v_bfe_u32 v2, v0, 1, 1
    v_mul_u32_u24 v2, 272, v2
    v_add_u32_e64 v255, v255, v2
    v_bfe_u32 v2, v0, 2, 1
    v_mul_u32_u24 v2, 768, v2
    v_add_u32_e64 v255, v255, v2
    v_bfe_u32 v2, v0, 3, 1
    v_mul_u32_u24 v2, 1344, v2
    v_add_u32_e64 v255, v255, v2
    v_bfe_u32 v2, v0, 4, 1
    v_mul_u32_u24 v2, 16512, v2
    v_add_u32 v255, v255, v2
    v_lshlrev_b32 v232, 7, v0
    v_lshrrev_b32 v2, 4, v0
    v_and_b32 v4, 3, v0
    v_lshrrev_b32 v5, 2, v0
    v_and_b32 v7, 1, v0
    v_lshlrev_b32_e64 v3, 4, v7
    v_mov_b32 v6, 0x3f80
    v_lshlrev_b32_e64 v6, v3, v6
    v_bfe_u32 v3, v0, 1, 3
    v_cmp_eq_u32 s[6:7], 0, v3
    s_nop 1
    v_cndmask_b32 v228, 0, v6, s[6:7]
    v_cmp_eq_u32 s[6:7], 1, v3
    s_nop 1
    v_cndmask_b32 v229, 0, v6, s[6:7]
    v_cmp_eq_u32 s[6:7], 2, v3
    s_nop 1
    v_cndmask_b32 v230, 0, v6, s[6:7]
    v_cmp_eq_u32 s[6:7], 3, v3
    s_nop 1
    v_cndmask_b32 v231, 0, v6, s[6:7]
    v_bfe_u32 v6, v5, 1, 2
    v_lshrrev_b32 v3, 1, v4
    v_xor_b32 v6, v6, v3
    v_lshlrev_b32_e64 v6, 4, v6
    v_lshl_add_u32 v6, v7, 3, v6
    v_lshl_add_u32 v6, v5, 6, v6
    s_add_u32 s5, s42, 32768
    v_add_u32 v238, s5, v6
    v_xor_b32 v239, 32, v238
    v_xor_b32 v6, v4, v2
    v_lshlrev_b32 v6, 3, v6
    v_lshl_add_u32 v6, v5, 5, v6
    s_add_u32 s5, s42, 65536
    v_add_u32_e64 v250, s5, v6
    v_bfe_u32 v6, v0, 3, 1
    v_xor_b32 v6, v6, v30
    v_lshlrev_b32 v6, 4, v6
    v_lshl_add_u32 v6, v29, 1, v6
    s_add_u32 s5, s42, 147456
    v_add_u32_e64 v252, s5, v6
    s_mul_i32 s6, s52, 1408
    s_min_u32 s6, s6, 1407616
    s_add_u32 s6, s6, 60
    s_add_u32 s6, s20, s6
    s_addc_u32 s7, s21, 0
    s_load_dwordx2 vcc, s[6:7], 0
    s_load_dwordx2 vcc, s[6:7], 128
    s_load_dwordx2 vcc, s[6:7], 256
    s_load_dwordx2 vcc, s[6:7], 384
    s_waitcnt vmcnt(11)
    s_barrier
    s_bfe_u32 s3, s69, 0x30010
    s_lshl_b32 s5, s3, 7
    s_mul_i32 s6, s3, s77
    s_add_u32 s5, s5, s0
    s_add_u32 s6, s6, s1
    s_add_u32 m0, s42, 40960
    s_nop 0
    buffer_load_dwordx4 v8, s[8:11], s5 offen offset:0  lds
    s_add_u32 m0, s71, 57344
    s_nop 0
    buffer_load_dwordx4 v12, s[12:15], s6 offen offset:0  lds
    buffer_load_dwordx4 v13, s[12:15], s6 offen offset:1024  lds
    s_add_u32 m0, s42, 40960
    s_nop 0
    buffer_load_dwordx4 v9, s[8:11], s5 offen offset:1024  lds
    s_add_u32 m0, s71, 65536
    s_nop 0
    buffer_load_dwordx4 v14, s[12:15], s6 offen offset:0  lds
    buffer_load_dwordx4 v15, s[12:15], s6 offen offset:1024  lds
    s_add_u32 m0, s42, 40960
    s_nop 0
    buffer_load_dwordx4 v10, s[8:11], s5 offen offset:2048  lds
    s_add_u32 m0, s71, 73728
    s_nop 0
    buffer_load_dwordx4 v16, s[12:15], s6 offen offset:0  lds
    buffer_load_dwordx4 v17, s[12:15], s6 offen offset:1024  lds
    s_add_u32 m0, s42, 40960
    s_nop 0
    buffer_load_dwordx4 v11, s[8:11], s5 offen offset:3072  lds
    s_lshl_b32 s5, s67, 10
    s_add_u32 m0, s5, 154624
    s_lshr_b32 s6, s63, 1
    s_lshl_b32 s6, s6, 12
    s_add_u32 s5, s5, s6
    buffer_load_dwordx4 v251, s[32:35], s5 offen lds
    s_mul_i32 s6, s52, 1408
    s_min_u32 s6, s6, 1407616
    s_add_u32 s6, s6, 60
    s_add_u32 s6, s20, s6
    s_addc_u32 s7, s21, 0
    s_load_dwordx2 vcc, s[6:7], 512
    s_load_dwordx2 vcc, s[6:7], 640
    s_load_dwordx2 vcc, s[6:7], 768
    s_load_dwordx2 vcc, s[6:7], 896
    s_waitcnt vmcnt(11)
    s_barrier
    s_bfe_u32 s3, s69, 0x30014
    s_lshl_b32 s5, s3, 7
    s_mul_i32 s6, s3, s77
    s_add_u32 s5, s5, s0
    s_add_u32 s6, s6, s1
    s_add_u32 m0, s42, 81920
    s_nop 0
    buffer_load_dwordx4 v8, s[8:11], s5 offen offset:0  lds
    s_add_u32 m0, s71, 98304
    s_nop 0
    buffer_load_dwordx4 v12, s[12:15], s6 offen offset:0  lds
    buffer_load_dwordx4 v13, s[12:15], s6 offen offset:1024  lds
    s_add_u32 m0, s42, 81920
    s_nop 0
    buffer_load_dwordx4 v9, s[8:11], s5 offen offset:1024  lds
    s_add_u32 m0, s71, 106496
    s_nop 0
    buffer_load_dwordx4 v14, s[12:15], s6 offen offset:0  lds
    buffer_load_dwordx4 v15, s[12:15], s6 offen offset:1024  lds
    s_add_u32 m0, s42, 81920
    s_nop 0
    buffer_load_dwordx4 v10, s[8:11], s5 offen offset:2048  lds
    s_add_u32 m0, s71, 114688
    s_nop 0
    buffer_load_dwordx4 v16, s[12:15], s6 offen offset:0  lds
    buffer_load_dwordx4 v17, s[12:15], s6 offen offset:1024  lds
    s_add_u32 m0, s42, 81920
    s_nop 0
    buffer_load_dwordx4 v11, s[8:11], s5 offen offset:3072  lds
    s_lshl2_add_u32 s3, s63, s67
    s_xor_b32 s3, s3, 4
    s_mul_i32 s72, s60, 491520
    s_lshr_b32 s5, s3, 1
    s_lshl_b32 s5, s5, 12
    s_add_u32 s72, s72, s5
    s_and_b32 s5, s3, 1
    s_lshl_b32 s5, s5, 9
    s_add_u32 s72, s72, s5
    s_add_u32 s72, s72, 2277376
    s_add_u32 s73, s72, 245760
    s_mul_i32 s6, s52, 1408
    s_min_u32 s6, s6, 1407616
    s_add_u32 s6, s6, 60
    s_add_u32 s6, s20, s6
    s_addc_u32 s7, s21, 0
    s_load_dwordx2 vcc, s[6:7], 1024
    s_load_dwordx2 vcc, s[6:7], 1152
    s_load_dwordx2 vcc, s[6:7], 1280
    s_mul_i32 s6, s52, 512
    s_min_u32 s6, s6, 523776
    s_add_u32 s6, s6, 60
    s_add_u32 s6, s24, s6
    s_addc_u32 s7, s25, 0
    s_load_dwordx2 vcc, s[6:7], 0
    s_waitcnt vmcnt(11)
    s_barrier
    s_bfe_u32 s3, s69, 0x30018
    s_lshl_b32 s5, s3, 7
    s_mul_i32 s6, s3, s77
    s_add_u32 s5, s5, s0
    s_add_u32 s6, s6, s1
    s_add_u32 m0, s42, 0
    s_nop 0
    buffer_load_dwordx4 v8, s[8:11], s5 offen offset:0  lds
    s_add_u32 m0, s71, 16384
    s_nop 0
    buffer_load_dwordx4 v12, s[12:15], s6 offen offset:0  lds
    buffer_load_dwordx4 v13, s[12:15], s6 offen offset:1024  lds
    s_add_u32 m0, s42, 0
    s_nop 0
    buffer_load_dwordx4 v9, s[8:11], s5 offen offset:1024  lds
    s_add_u32 m0, s71, 24576
    s_nop 0
    buffer_load_dwordx4 v14, s[12:15], s6 offen offset:0  lds
    buffer_load_dwordx4 v15, s[12:15], s6 offen offset:1024  lds
    s_add_u32 m0, s42, 0
    s_nop 0
    buffer_load_dwordx4 v10, s[8:11], s5 offen offset:2048  lds
    s_add_u32 m0, s71, 32768
    s_nop 0
    buffer_load_dwordx4 v16, s[12:15], s6 offen offset:0  lds
    buffer_load_dwordx4 v17, s[12:15], s6 offen offset:1024  lds
    s_add_u32 m0, s42, 0
    s_nop 0
    buffer_load_dwordx4 v11, s[8:11], s5 offen offset:3072  lds
    s_mul_i32 s6, s52, 512
    s_min_u32 s6, s6, 523776
    s_add_u32 s6, s6, 60
    s_add_u32 s6, s24, s6
    s_addc_u32 s7, s25, 0
    s_load_dwordx2 vcc, s[6:7], 128
    s_load_dwordx2 vcc, s[6:7], 256
    s_load_dwordx2 vcc, s[6:7], 384
    s_waitcnt vmcnt(10)
    s_barrier
    s_bfe_u32 s3, s69, 0x3001c
    s_lshl_b32 s5, s3, 7
    s_mul_i32 s6, s3, s77
    s_add_u32 s5, s5, s0
    s_add_u32 s6, s6, s1
    s_add_u32 m0, s42, 40960
    s_nop 0
    buffer_load_dwordx4 v8, s[8:11], s5 offen offset:0  lds
    s_add_u32 m0, s71, 57344
    s_nop 0
    buffer_load_dwordx4 v12, s[12:15], s6 offen offset:0  lds
    buffer_load_dwordx4 v13, s[12:15], s6 offen offset:1024  lds
    s_add_u32 m0, s42, 40960
    s_nop 0
    buffer_load_dwordx4 v9, s[8:11], s5 offen offset:1024  lds
    s_add_u32 m0, s71, 65536
    s_nop 0
    buffer_load_dwordx4 v14, s[12:15], s6 offen offset:0  lds
    buffer_load_dwordx4 v15, s[12:15], s6 offen offset:1024  lds
    s_add_u32 m0, s42, 40960
    s_nop 0
    buffer_load_dwordx4 v10, s[8:11], s5 offen offset:2048  lds
    s_add_u32 m0, s71, 73728
    s_nop 0
    buffer_load_dwordx4 v16, s[12:15], s6 offen offset:0  lds
    buffer_load_dwordx4 v17, s[12:15], s6 offen offset:1024  lds
    s_add_u32 m0, s42, 40960
    s_nop 0
    buffer_load_dwordx4 v11, s[8:11], s5 offen offset:3072  lds
    v_lshl_or_b32 v61, v19, 16, v19
    s_waitcnt vmcnt(10)
    s_barrier
    buffer_load_dwordx4 v[32:35], v251, s[16:19], s40 offen offset:0 sc1
    buffer_load_dwordx4 v[36:39], v251, s[16:19], s40 offen offset:1024 sc1
    buffer_load_dwordx4 v[40:43], v251, s[16:19], s40 offen offset:2048 sc1
    buffer_load_dwordx4 v[44:47], v251, s[16:19], s40 offen offset:3072 sc1
    buffer_load_dwordx4 v[48:51], v29, s[16:19], s41 offen sc1
    buffer_store_dwordx4 v[72:75], v233, s[16:19], s72 offen offset:0 sc1
    buffer_store_dwordx4 v[72:75], v233, s[16:19], s72 offen offset:2048 sc1
    s_add_u32 m0, s42, 131072
    s_add_u32 s6, s56, 0
    s_lshl_b32 s6, s6, 15
    s_add_u32 s6, s6, s51
    buffer_load_dwordx4 v20, s[20:23], s6 offen offset:0 lds
    buffer_load_dwordx4 v21, s[20:23], s6 offen offset:1024 lds
    buffer_load_dwordx4 v22, s[20:23], s6 offen offset:2048 lds
    buffer_load_dwordx4 v23, s[20:23], s6 offen offset:3072 lds
    s_waitcnt vmcnt(11)
    s_barrier
    v_mov_b32_e64 v18, v78
    s_sub_u32 s48, s47, 1048576
    s_lshr_b32 s48, s48, 1
    s_add_u32 s48, s48, 1114112
    s_and_b32 s5, s60, 3
    s_lshl_b32 s5, s5, 8
    s_add_u32 s52, s48, s5
    s_add_u32 s46, s46, s5
    s_lshr_b32 s5, s60, 2
    s_cmp_eq_u32 s5, s67
    s_cbranch_scc0 L_nopre2
    s_mov_b64 exec, 0xffff
    s_xor_b32 s5, s52, 4096
    buffer_store_dwordx4 v[72:75], v251, s[16:19], s5 offen offset:0 sc1
    s_mov_b64 exec, -1
L_nopre2:
    buffer_store_dwordx4 v[72:75], v251, s[16:19], s53 offen offset:0 sc1
    s_mov_b64 exec, 0xff
    buffer_store_dwordx4 v[72:75], v251, s[16:19], s54 offen offset:0 sc1
    s_mov_b64 exec, -1
    buffer_store_dwordx4 v[72:75], v233, s[16:19], s73 offen offset:0 sc1
    buffer_store_dwordx4 v[72:75], v233, s[16:19], s73 offen offset:2048 sc1
    s_add_u32 m0, s42, 81920
    s_add_u32 s6, s57, 0
    s_lshl_b32 s6, s6, 15
    s_add_u32 s6, s6, s51
    buffer_load_dwordx4 v20, s[20:23], s6 offen offset:0 lds
    buffer_load_dwordx4 v21, s[20:23], s6 offen offset:1024 lds
    buffer_load_dwordx4 v22, s[20:23], s6 offen offset:2048 lds
    buffer_load_dwordx4 v23, s[20:23], s6 offen offset:3072 lds
    s_waitcnt vmcnt(14)
    s_waitcnt lgkmcnt(0)
    s_mov_b32 s3, 0
L_Hchk0:
    v_cmp_ne_u32 vcc, s68, v35
    v_cmp_ne_u32 s[0:1], s68, v39
    v_cmp_ne_u32 s[4:5], s68, v43
    v_cmp_ne_u32 s[6:7], s68, v47
    s_or_b64 s[0:1], s[0:1], vcc
    v_cmp_ne_u32 vcc, s68, v51
    s_or_b64 s[4:5], s[4:5], s[6:7]
    s_or_b64 s[0:1], s[0:1], s[4:5]
    s_or_b64 s[0:1], s[0:1], vcc
    s_cbranch_scc0 L_Hok0
    s_add_u32 s3, s3, 1
    s_cmp_gt_u32 s3, 200000
    s_cbranch_scc1 L_Hok0
    buffer_load_dwordx4 v[32:35], v251, s[16:19], s40 offen offset:0 sc1
    buffer_load_dwordx4 v[36:39], v251, s[16:19], s40 offen offset:1024 sc1
    buffer_load_dwordx4 v[40:43], v251, s[16:19], s40 offen offset:2048 sc1
    buffer_load_dwordx4 v[44:47], v251, s[16:19], s40 offen offset:3072 sc1
    buffer_load_dwordx4 v[48:51], v29, s[16:19], s41 offen sc1
    s_waitcnt vmcnt(0)
    s_branch L_Hchk0
L_Hok0:
    v_add_f32 v32, v32, v36
    v_add_f32 v40, v40, v44
    v_add_f32 v33, v33, v37
    v_add_f32 v41, v41, v45
    v_add_f32 v34, v34, v38
    v_add_f32 v42, v42, v46
    v_mov_b32 v35, 0
    v_add_f32 v32, v32, v40
    v_add_f32 v34, v34, v42
    v_add_f32 v33, v33, v41
    v_lshlrev_b32 v52, 16, v49
    v_and_b32 v53, 0xffff0000, v49
    v_permlane32_swap_b32 v32, v34
    v_permlane32_swap_b32 v33, v35
    v_add_f32 v32, v32, v34
    v_add_f32 v33, v33, v35
    v_add_f32_e64 v52, v52, v53
    ds_write2_b32 v77, v52, v50 offset0:1 offset1:0
    v_mov_b32 v50, v48
    v_mov_b32 v51, 0
    v_permlane16_swap_b32 v32, v33
    v_add_f32 v32, v32, v33
    ds_write_b128 v76, v[48:51]
    v_cvt_pk_bf16_f32 v60, v32, v32
    v_lshlrev_b32 v34, 16, v60
    v_sub_f32 v34, v32, v34
    v_cvt_pk_bf16_f32 v62, v34, v34
    ds_write_b128 v31, v[60:63]
    s_add_u32 m0, s42, 98304
    s_add_u32 s6, s58, 0
    s_lshl_b32 s6, s6, 15
    s_add_u32 s6, s6, s51
    buffer_load_dwordx4 v20, s[20:23], s6 offen offset:0 lds
    buffer_load_dwordx4 v21, s[20:23], s6 offen offset:1024 lds
    buffer_load_dwordx4 v22, s[20:23], s6 offen offset:2048 lds
    buffer_load_dwordx4 v23, s[20:23], s6 offen offset:3072 lds
    s_waitcnt lgkmcnt(0)
    s_barrier
    s_setprio 0
    s_add_u32 m0, s42, 114688
    s_add_u32 s6, s59, 0
    s_lshl_b32 s6, s6, 15
    s_add_u32 s6, s6, s51
    buffer_load_dwordx4 v20, s[20:23], s6 offen offset:0 lds
    buffer_load_dwordx4 v21, s[20:23], s6 offen offset:1024 lds
    buffer_load_dwordx4 v22, s[20:23], s6 offen offset:2048 lds
    buffer_load_dwordx4 v23, s[20:23], s6 offen offset:3072 lds
    s_lshl_b32 s5, s60, 7
    s_add_u32 s55, s5, s43
    s_xor_b32 s55, s55, 8192
    s_waitcnt vmcnt(12)
    s_mov_b32 exec_hi, 0
    buffer_store_dword v1, v236, s[16:19], s55 offen offset:0 sc1
    s_mov_b32 exec_hi, -1
    s_mov_b32 exec_hi, 0
    buffer_store_dword v1, v236, s[16:19], s50 offen offset:0 sc1
    s_mov_b32 exec_hi, -1
    s_add_u32 s50, s50, 4096
    s_mov_b32 exec_hi, 0
    buffer_store_dword v1, v236, s[16:19], s50 offen offset:0 sc1
    s_mov_b32 exec_hi, -1
    s_add_u32 s50, s50, 4096
    s_add_u32 m0, s42, 0
    s_add_u32 s6, s56, 2
    s_lshl_b32 s6, s6, 15
    s_add_u32 s6, s6, s51
    buffer_load_dwordx4 v20, s[20:23], s6 offen offset:0 lds
    buffer_load_dwordx4 v21, s[20:23], s6 offen offset:1024 lds
    buffer_load_dwordx4 v22, s[20:23], s6 offen offset:2048 lds
    buffer_load_dwordx4 v23, s[20:23], s6 offen offset:3072 lds
    s_add_u32 m0, s42, 16384
    s_add_u32 s6, s57, 2
    s_lshl_b32 s6, s6, 15
    s_add_u32 s6, s6, s51
    buffer_load_dwordx4 v20, s[20:23], s6 offen offset:0 lds
    buffer_load_dwordx4 v21, s[20:23], s6 offen offset:1024 lds
    buffer_load_dwordx4 v22, s[20:23], s6 offen offset:2048 lds
    buffer_load_dwordx4 v23, s[20:23], s6 offen offset:3072 lds
    buffer_load_dwordx4 v[240:243], v248, s[8:11], 0 offen
    buffer_load_dwordx4 v[244:247], v249, s[36:39], s51 offen
    ds_read_b64_tr_b16 v[120:121], v234
    ds_read_b64_tr_b16 v[122:123], v234 offset:128
    ds_read_b32 v124, v237
    ds_read_b32 v126, v237 offset:512
    v_and_b32_e64 v3, 4, v0
    v_cmp_eq_u32 vcc, 0, v3
    s_waitcnt lgkmcnt(0)
    s_nop 0
    v_cndmask_b32 v116, 0, v120, vcc
    v_cndmask_b32 v117, 0, v121, vcc
    v_cndmask_b32 v118, 0, v122, vcc
    v_cndmask_b32 v119, 0, v123, vcc
    v_cndmask_b32 v120, v120, 0, vcc
    v_cndmask_b32 v121, v121, 0, vcc
    v_cndmask_b32 v122, v122, 0, vcc
    v_cndmask_b32 v123, v123, 0, vcc
    v_mul_f32 v124, 0x3fb8aa3b, v124
    v_mul_f32 v126, 0x3fb8aa3b, v126
    v_and_b32_e64 v2, 1, v0
    v_cmp_eq_u32 vcc, 1, v2
    s_barrier
    s_mov_b64 exec, 0xffff
    buffer_load_dword v235, v232, s[16:19], s43 offen sc1
    s_mov_b64 exec, -1
    ds_read_b64_tr_b16 v[32:33], v238 offset:0
    ds_read_b64_tr_b16 v[36:37], v239 offset:0
    ds_read_b64_tr_b16 v[40:41], v250 offset:0
    ds_read_b64_tr_b16 v[34:35], v238 offset:1024
    ds_read_b64_tr_b16 v[38:39], v239 offset:1024
    ds_read_b64_tr_b16 v[42:43], v250 offset:512
    ds_read_b64_tr_b16 v[44:45], v238 offset:2048
    ds_read_b64_tr_b16 v[48:49], v239 offset:2048
    ds_read_b64_tr_b16 v[52:53], v250 offset:1024
    ds_read_b64_tr_b16 v[46:47], v238 offset:3072
    ds_read_b64_tr_b16 v[50:51], v239 offset:3072
    ds_read_b64_tr_b16 v[54:55], v250 offset:1536
    s_waitcnt lgkmcnt(6)
    v_mfma_f32_16x16x32_bf16 v[80:83], v[32:35], v[40:43], 0
    v_mfma_f32_16x16x32_bf16 v[84:87], v[36:39], v[40:43], 0
    ds_read_b64_tr_b16 v[56:57], v238 offset:16384
    ds_read_b64_tr_b16 v[60:61], v239 offset:16384
    ds_read_b64_tr_b16 v[64:65], v250 offset:2048
    ds_read_b64_tr_b16 v[58:59], v238 offset:17408
    ds_read_b64_tr_b16 v[62:63], v239 offset:17408
    ds_read_b64_tr_b16 v[66:67], v250 offset:2560
    s_waitcnt lgkmcnt(6)
    v_mfma_f32_16x16x32_bf16 v[80:83], v[44:47], v[52:55], v[80:83]
    v_mfma_f32_16x16x32_bf16 v[84:87], v[48:51], v[52:55], v[84:87]
    ds_read_b64_tr_b16 v[68:69], v238 offset:18432
    ds_read_b64_tr_b16 v[72:73], v239 offset:18432
    ds_read_b64_tr_b16 v[76:77], v250 offset:3072
    ds_read_b64_tr_b16 v[70:71], v238 offset:19456
    ds_read_b64_tr_b16 v[74:75], v239 offset:19456
    ds_read_b64_tr_b16 v[78:79], v250 offset:3584
    s_waitcnt lgkmcnt(6)
    v_mfma_f32_16x16x32_bf16 v[80:83], v[56:59], v[64:67], v[80:83]
    v_mfma_f32_16x16x32_bf16 v[84:87], v[60:63], v[64:67], v[84:87]
    s_waitcnt lgkmcnt(0)
    v_mfma_f32_16x16x32_bf16 v[80:83], v[68:71], v[76:79], v[80:83]
    v_mfma_f32_16x16x32_bf16 v[84:87], v[72:75], v[76:79], v[84:87]
    v_mfma_f32_16x16x32_bf16 v[88:91], v[32:35], v[24:27], 0
    v_mfma_f32_16x16x32_bf16 v[92:95], v[36:39], v[24:27], 0
    s_nop 4
    v_cvt_pk_bf16_f32 v96, v80, v81
    v_cvt_pk_bf16_f32 v97, v82, v83
    v_cvt_pk_bf16_f32 v98, v84, v85
    v_cvt_pk_bf16_f32 v99, v86, v87
    buffer_store_dwordx4 v[96:99], v251, s[16:19], s53 offen sc1
    v_mfma_f32_16x16x32_bf16 v[88:91], v[44:47], v[24:27], v[88:91]
    v_mfma_f32_16x16x32_bf16 v[92:95], v[48:51], v[24:27], v[92:95]
    v_mfma_f32_16x16x32_bf16 v[88:91], v[56:59], v[24:27], v[88:91]
    v_mfma_f32_16x16x32_bf16 v[92:95], v[60:63], v[24:27], v[92:95]
    v_mfma_f32_16x16x32_bf16 v[88:91], v[68:71], v[24:27], v[88:91]
    v_mfma_f32_16x16x32_bf16 v[92:95], v[72:75], v[24:27], v[92:95]
    s_nop 7
    v_cndmask_b32 v88, v88, v92, vcc
    v_cndmask_b32 v89, v89, v93, vcc
    v_cndmask_b32 v90, v90, v94, vcc
    v_cndmask_b32 v91, v91, v95, vcc
    s_mov_b32 exec_lo, 0x00030003
    s_mov_b32 exec_hi, 0x00030003
    buffer_store_dwordx4 v[88:91], v253, s[16:19], s54 offen sc1
    s_mov_b64 exec, -1
    s_waitcnt lgkmcnt(0)
    s_waitcnt vmcnt(3)
    s_barrier
    ds_read_b128 v[100:103], v252 offset:0
    ds_read_b128 v[104:107], v252 offset:1024
    ds_read_b128 v[108:111], v252 offset:2048
    ds_read_b128 v[112:115], v252 offset:3072
    s_waitcnt lgkmcnt(0)
    s_barrier
    v_mfma_f32_32x32x16_bf16 v[32:47], v[116:119], v[100:103], 0
    v_mfma_f32_32x32x16_bf16 v[32:47], v[120:123], v[104:107], v[32:47]
    v_mfma_f32_32x32x16_bf16 v[48:63], v[116:119], v[108:111], 0
    v_mfma_f32_32x32x16_bf16 v[48:63], v[120:123], v[112:115], v[48:63]
    s_nop 9
    v_max3_f32 v130, v32, v33, v34
    v_min3_f32 v128, v32, v33, v34
    v_max3_f32 v130, v130, v35, v36
    v_min3_f32 v128, v128, v35, v36
    v_max3_f32 v130, v130, v37, v38
    v_min3_f32 v128, v128, v37, v38
    v_max3_f32 v130, v130, v39, v40
    v_min3_f32 v128, v128, v39, v40
    v_max3_f32 v130, v130, v41, v42
    v_min3_f32 v128, v128, v41, v42
    v_max3_f32 v130, v130, v43, v44
    v_min3_f32 v128, v128, v43, v44
    v_max3_f32 v130, v130, v45, v46
    v_min3_f32 v128, v128, v45, v46
    v_max_f32 v130, v130, v47
    v_min_f32 v128, v128, v47
    v_mul_f32 v130, v130, v124
    v_mul_f32 v128, v128, v124
    v_pk_fma_f32 v[64:65], v[32:33], v[124:125], v[130:131] op_sel_hi:[1,0,0] neg_lo:[0,0,1] neg_hi:[0,0,1]
    v_pk_fma_f32 v[32:33], v[32:33], v[124:125], v[128:129] op_sel_hi:[1,0,0] neg_lo:[1,0,0] neg_hi:[1,0,0]
    v_pk_fma_f32 v[66:67], v[34:35], v[124:125], v[130:131] op_sel_hi:[1,0,0] neg_lo:[0,0,1] neg_hi:[0,0,1]
    v_pk_fma_f32 v[34:35], v[34:35], v[124:125], v[128:129] op_sel_hi:[1,0,0] neg_lo:[1,0,0] neg_hi:[1,0,0]
    v_pk_fma_f32 v[68:69], v[36:37], v[124:125], v[130:131] op_sel_hi:[1,0,0] neg_lo:[0,0,1] neg_hi:[0,0,1]
    v_pk_fma_f32 v[36:37], v[36:37], v[124:125], v[128:129] op_sel_hi:[1,0,0] neg_lo:[1,0,0] neg_hi:[1,0,0]
    v_pk_fma_f32 v[70:71], v[38:39], v[124:125], v[130:131] op_sel_hi:[1,0,0] neg_lo:[0,0,1] neg_hi:[0,0,1]
    v_pk_fma_f32 v[38:39], v[38:39], v[124:125], v[128:129] op_sel_hi:[1,0,0] neg_lo:[1,0,0] neg_hi:[1,0,0]
    v_pk_fma_f32 v[72:73], v[40:41], v[124:125], v[130:131] op_sel_hi:[1,0,0] neg_lo:[0,0,1] neg_hi:[0,0,1]
    v_pk_fma_f32 v[40:41], v[40:41], v[124:125], v[128:129] op_sel_hi:[1,0,0] neg_lo:[1,0,0] neg_hi:[1,0,0]
    v_pk_fma_f32 v[74:75], v[42:43], v[124:125], v[130:131] op_sel_hi:[1,0,0] neg_lo:[0,0,1] neg_hi:[0,0,1]
    v_pk_fma_f32 v[42:43], v[42:43], v[124:125], v[128:129] op_sel_hi:[1,0,0] neg_lo:[1,0,0] neg_hi:[1,0,0]
    v_pk_fma_f32 v[76:77], v[44:45], v[124:125], v[130:131] op_sel_hi:[1,0,0] neg_lo:[0,0,1] neg_hi:[0,0,1]
    v_pk_fma_f32 v[44:45], v[44:45], v[124:125], v[128:129] op_sel_hi:[1,0,0] neg_lo:[1,0,0] neg_hi:[1,0,0]
    v_pk_fma_f32 v[78:79], v[46:47], v[124:125], v[130:131] op_sel_hi:[1,0,0] neg_lo:[0,0,1] neg_hi:[0,0,1]
    v_pk_fma_f32 v[46:47], v[46:47], v[124:125], v[128:129] op_sel_hi:[1,0,0] neg_lo:[1,0,0] neg_hi:[1,0,0]
    v_exp_f32 v64, v64
    v_exp_f32 v65, v65
    v_exp_f32 v66, v66
    v_exp_f32 v67, v67
    v_exp_f32 v68, v68
    v_exp_f32 v69, v69
    v_exp_f32 v70, v70
    v_exp_f32 v71, v71
    v_exp_f32 v72, v72
    v_exp_f32 v73, v73
    v_exp_f32 v74, v74
    v_exp_f32 v75, v75
    v_exp_f32 v76, v76
    v_exp_f32 v77, v77
    v_exp_f32 v78, v78
    v_exp_f32 v79, v79
    v_exp_f32 v32, v32
    v_exp_f32 v33, v33
    v_exp_f32 v34, v34
    v_exp_f32 v35, v35
    v_exp_f32 v36, v36
    v_exp_f32 v37, v37
    v_exp_f32 v38, v38
    v_exp_f32 v39, v39
    v_exp_f32 v40, v40
    v_exp_f32 v41, v41
    v_exp_f32 v42, v42
    v_exp_f32 v43, v43
    v_exp_f32 v44, v44
    v_exp_f32 v45, v45
    v_exp_f32 v46, v46
    v_exp_f32_e64 v47, v47
    s_waitcnt vmcnt(2)
    v_cmp_ne_u32 vcc, s68, v235
    s_nop 0
    s_and_b64 vcc, vcc, 0xffff
    s_cbranch_scc0 L_pk_7
    s_mov_b64 exec, 0xffff
    s_mov_b32 s7, 0
L_poll_8:
    buffer_load_dword v235, v232, s[16:19], s43 offen offset:0 sc1
    s_add_u32 s7, s7, 1
    s_cmp_gt_u32 s7, 200000
    s_cbranch_scc1 L_polld_9
    s_waitcnt vmcnt(0)
    v_cmp_ne_u32 vcc, s68, v235
    s_nop 0
    s_cbranch_vccz L_polld_9
    s_sleep 6
    s_branch L_poll_8
L_polld_9:
    s_waitcnt vmcnt(0)
    s_mov_b64 exec, -1
L_pk_7:
    s_lshr_b32 s5, s60, 2
    s_cmp_eq_u32 s5, s67
    s_cbranch_scc0 L_nol1
    s_add_u32 s5, s46, 0
    buffer_load_dwordx4 v[100:103], v18, s[16:19], s5 offen sc1
    s_add_u32 s5, s46, 4096
    buffer_load_dwordx4 v[104:107], v18, s[16:19], s5 offen sc1
    s_add_u32 s5, s46, 8192
    buffer_load_dwordx4 v[108:111], v18, s[16:19], s5 offen sc1
    s_add_u32 s5, s46, 12288
    buffer_load_dwordx4 v[112:115], v18, s[16:19], s5 offen sc1
L_nol1:
    v_pk_add_f32 v[80:81], v[64:65], v[66:67]
    v_pk_add_f32 v[82:83], v[68:69], v[70:71]
    v_pk_add_f32 v[84:85], v[32:33], v[34:35]
    v_pk_add_f32 v[86:87], v[36:37], v[38:39]
    v_pk_add_f32 v[80:81], v[80:81], v[72:73]
    v_pk_add_f32 v[84:85], v[84:85], v[40:41]
    v_pk_add_f32 v[82:83], v[82:83], v[74:75]
    v_pk_add_f32 v[86:87], v[86:87], v[42:43]
    v_pk_add_f32 v[80:81], v[80:81], v[76:77]
    v_pk_add_f32 v[84:85], v[84:85], v[44:45]
    v_pk_add_f32 v[82:83], v[82:83], v[78:79]
    v_pk_add_f32 v[86:87], v[86:87], v[46:47]
    v_pk_add_f32 v[80:81], v[80:81], v[82:83]
    v_pk_add_f32 v[84:85], v[84:85], v[86:87]
    v_add_f32 v80, v80, v81
    v_add_f32 v84, v84, v85
    v_rcp_f32 v80, v80
    v_rcp_f32 v84, v84
    v_pk_mul_f32 v[64:65], v[64:65], v[80:81] op_sel_hi:[1,0]
    v_pk_mul_f32 v[66:67], v[66:67], v[80:81] op_sel_hi:[1,0]
    v_pk_mul_f32 v[68:69], v[68:69], v[80:81] op_sel_hi:[1,0]
    v_pk_mul_f32 v[70:71], v[70:71], v[80:81] op_sel_hi:[1,0]
    v_pk_mul_f32 v[72:73], v[72:73], v[80:81] op_sel_hi:[1,0]
    v_pk_mul_f32 v[74:75], v[74:75], v[80:81] op_sel_hi:[1,0]
    v_pk_mul_f32 v[76:77], v[76:77], v[80:81] op_sel_hi:[1,0]
    v_pk_mul_f32 v[78:79], v[78:79], v[80:81] op_sel_hi:[1,0]
    v_cvt_pk_bf16_f32 v196, v64, v65
    v_cvt_pk_bf16_f32 v197, v66, v67
    v_cvt_pk_bf16_f32 v200, v68, v69
    v_cvt_pk_bf16_f32 v201, v70, v71
    v_cvt_pk_bf16_f32 v204, v72, v73
    v_cvt_pk_bf16_f32 v205, v74, v75
    v_cvt_pk_bf16_f32 v208, v76, v77
    v_cvt_pk_bf16_f32 v209, v78, v79
    v_pk_mul_f32 v[32:33], v[32:33], v[84:85] op_sel_hi:[1,0]
    v_pk_mul_f32 v[34:35], v[34:35], v[84:85] op_sel_hi:[1,0]
    v_pk_mul_f32 v[36:37], v[36:37], v[84:85] op_sel_hi:[1,0]
    v_pk_mul_f32 v[38:39], v[38:39], v[84:85] op_sel_hi:[1,0]
    v_pk_mul_f32 v[40:41], v[40:41], v[84:85] op_sel_hi:[1,0]
    v_pk_mul_f32 v[42:43], v[42:43], v[84:85] op_sel_hi:[1,0]
    v_pk_mul_f32 v[44:45], v[44:45], v[84:85] op_sel_hi:[1,0]
    v_pk_mul_f32 v[46:47], v[46:47], v[84:85] op_sel_hi:[1,0]
    v_cvt_pk_bf16_f32 v198, v32, v33
    v_cvt_pk_bf16_f32 v199, v34, v35
    v_cvt_pk_bf16_f32 v202, v36, v37
    v_cvt_pk_bf16_f32 v203, v38, v39
    v_cvt_pk_bf16_f32 v206, v40, v41
    v_cvt_pk_bf16_f32 v207, v42, v43
    v_cvt_pk_bf16_f32 v210, v44, v45
    v_cvt_pk_bf16_f32 v211, v46, v47
    v_permlane32_swap_b32 v196, v204
    v_permlane32_swap_b32 v200, v208
    v_permlane32_swap_b32 v197, v205
    v_permlane32_swap_b32 v201, v209
    v_permlane32_swap_b32 v198, v206
    v_permlane32_swap_b32 v202, v210
    v_permlane32_swap_b32 v199, v207
    v_permlane32_swap_b32 v203, v211
    v_permlane16_swap_b32 v196, v200
    v_permlane16_swap_b32 v204, v208
    v_permlane16_swap_b32 v197, v201
    v_permlane16_swap_b32 v205, v209
    v_permlane16_swap_b32 v198, v202
    v_permlane16_swap_b32 v206, v210
    v_permlane16_swap_b32 v199, v203
    v_permlane16_swap_b32 v207, v211
    v_max3_f32 v130, v48, v49, v50
    v_min3_f32 v128, v48, v49, v50
    v_max3_f32 v130, v130, v51, v52
    v_min3_f32 v128, v128, v51, v52
    v_max3_f32 v130, v130, v53, v54
    v_min3_f32 v128, v128, v53, v54
    v_max3_f32 v130, v130, v55, v56
    v_min3_f32 v128, v128, v55, v56
    v_max3_f32 v130, v130, v57, v58
    v_min3_f32 v128, v128, v57, v58
    v_max3_f32 v130, v130, v59, v60
    v_min3_f32 v128, v128, v59, v60
    v_max3_f32 v130, v130, v61, v62
    v_min3_f32 v128, v128, v61, v62
    v_max_f32 v130, v130, v63
    v_min_f32 v128, v128, v63
    v_mul_f32 v130, v130, v126
    v_mul_f32 v128, v128, v126
    v_fma_f32 v64, v48, v126, -v130
    v_fma_f32 v65, v49, v126, -v130
    v_fma_f32 v48, -v48, v126, v128
    v_fma_f32 v49, -v49, v126, v128
    v_fma_f32 v66, v50, v126, -v130
    v_fma_f32 v67, v51, v126, -v130
    v_fma_f32 v50, -v50, v126, v128
    v_fma_f32 v51, -v51, v126, v128
    v_fma_f32 v68, v52, v126, -v130
    v_fma_f32 v69, v53, v126, -v130
    v_fma_f32 v52, -v52, v126, v128
    v_fma_f32 v53, -v53, v126, v128
    v_fma_f32 v70, v54, v126, -v130
    v_fma_f32 v71, v55, v126, -v130
    v_fma_f32 v54, -v54, v126, v128
    v_fma_f32 v55, -v55, v126, v128
    v_fma_f32 v72, v56, v126, -v130
    v_fma_f32 v73, v57, v126, -v130
    v_fma_f32 v56, -v56, v126, v128
    v_fma_f32 v57, -v57, v126, v128
    v_fma_f32 v74, v58, v126, -v130
    v_fma_f32 v75, v59, v126, -v130
    v_fma_f32 v58, -v58, v126, v128
    v_fma_f32 v59, -v59, v126, v128
    v_fma_f32 v76, v60, v126, -v130
    v_fma_f32 v77, v61, v126, -v130
    v_fma_f32 v60, -v60, v126, v128
    v_fma_f32 v61, -v61, v126, v128
    v_fma_f32 v78, v62, v126, -v130
    v_fma_f32 v79, v63, v126, -v130
    v_fma_f32 v62, -v62, v126, v128
    v_fma_f32 v63, -v63, v126, v128
    v_exp_f32 v64, v64
    v_exp_f32 v65, v65
    v_exp_f32 v66, v66
    v_exp_f32 v67, v67
    v_exp_f32 v68, v68
    v_exp_f32 v69, v69
    v_exp_f32 v70, v70
    v_exp_f32_e64 v71, v71
    s_lshr_b32 s5, s60, 2
    s_cmp_eq_u32 s5, s67
    s_cbranch_scc0 L_nored
    s_mov_b32 s3, 0
    s_waitcnt vmcnt(0)
L_sw_10:
    v_max3_u32 v2, v103, v107, v111
    v_max_u32_e64 v2, v2, v115
    v_cmp_eq_u32 vcc, -1, v2
    s_nop 0
    s_cbranch_vccz L_swd_11
    s_add_u32 s3, s3, 1
    s_cmp_gt_u32 s3, 200000
    s_cbranch_scc1 L_swd_11
    s_add_u32 s5, s46, 0
    buffer_load_dwordx4 v[100:103], v18, s[16:19], s5 offen sc1
    s_add_u32 s5, s46, 4096
    buffer_load_dwordx4 v[104:107], v18, s[16:19], s5 offen sc1
    s_add_u32 s5, s46, 8192
    buffer_load_dwordx4 v[108:111], v18, s[16:19], s5 offen sc1
    s_add_u32 s5, s46, 12288
    buffer_load_dwordx4 v[112:115], v18, s[16:19], s5 offen sc1
    s_waitcnt vmcnt(0)
    s_branch L_sw_10
L_swd_11:
    v_mfma_f32_16x16x32_bf16 v[116:119], v[228:231], v[100:103], 0
    v_mfma_f32_16x16x32_bf16 v[116:119], v[228:231], v[104:107], v[116:119]
    v_mfma_f32_16x16x32_bf16 v[116:119], v[228:231], v[108:111], v[116:119]
    v_mfma_f32_16x16x32_bf16 v[116:119], v[228:231], v[112:115], v[116:119]
    s_nop 7
    v_cvt_pk_bf16_f32 v120, v116, v117
    v_cvt_pk_bf16_f32 v121, v118, v119
    v_mov_b32 v122, v120
    v_mov_b32 v123, v121
    s_nop 0
    v_permlane16_swap_b32 v120, v122
    v_permlane16_swap_b32 v121, v123
    s_mov_b64 exec, 0xffff
    buffer_store_dwordx4 v[120:123], v251, s[16:19], s52 offen sc1
    s_mov_b64 exec, -1
L_nored:
    buffer_load_dwordx4 v[88:91], v254, s[16:19], s47 offen offset:0 sc1
    buffer_load_dwordx4 v[92:95], v254, s[16:19], s47 offen offset:1024 sc1
    v_exp_f32 v72, v72
    v_exp_f32 v73, v73
    v_exp_f32 v74, v74
    v_exp_f32 v75, v75
    v_exp_f32 v76, v76
    v_exp_f32 v77, v77
    v_exp_f32 v78, v78
    v_exp_f32 v79, v79
    v_exp_f32 v48, v48
    v_exp_f32 v49, v49
    v_exp_f32 v50, v50
    v_exp_f32 v51, v51
    v_exp_f32 v52, v52
    v_exp_f32 v53, v53
    v_exp_f32 v54, v54
    v_exp_f32 v55, v55
    v_exp_f32 v56, v56
    v_exp_f32 v57, v57
    v_exp_f32 v58, v58
    v_exp_f32 v59, v59
    v_exp_f32 v60, v60
    v_exp_f32 v61, v61
    v_exp_f32 v62, v62
    v_exp_f32 v63, v63
    v_add_f32 v80, v64, v66
    v_add_f32 v81, v65, v67
    v_add_f32 v82, v68, v70
    v_add_f32 v83, v69, v71
    v_add_f32 v84, v48, v50
    v_add_f32 v85, v49, v51
    v_add_f32 v86, v52, v54
    v_add_f32 v87, v53, v55
    v_add_f32 v80, v80, v72
    v_add_f32 v81, v81, v73
    v_add_f32 v84, v84, v56
    v_add_f32 v85, v85, v57
    v_add_f32 v82, v82, v74
    v_add_f32 v83, v83, v75
    v_add_f32 v86, v86, v58
    v_add_f32 v87, v87, v59
    v_add_f32 v80, v80, v76
    v_add_f32 v81, v81, v77
    v_add_f32 v84, v84, v60
    v_add_f32 v85, v85, v61
    v_add_f32 v82, v82, v78
    v_add_f32 v83, v83, v79
    v_add_f32 v86, v86, v62
    v_add_f32 v87, v87, v63
    v_add_f32 v80, v80, v82
    v_add_f32 v81, v81, v83
    v_add_f32 v84, v84, v86
    v_add_f32 v85, v85, v87
    v_add_f32 v80, v80, v81
    v_add_f32 v84, v84, v85
    v_rcp_f32 v80, v80
    v_rcp_f32 v84, v84
    v_mul_f32 v64, v64, v80
    v_mul_f32 v65, v65, v80
    v_mul_f32 v66, v66, v80
    v_mul_f32 v67, v67, v80
    v_mul_f32 v68, v68, v80
    v_mul_f32 v69, v69, v80
    v_mul_f32 v70, v70, v80
    v_mul_f32 v71, v71, v80
    v_mul_f32 v72, v72, v80
    v_mul_f32 v73, v73, v80
    v_mul_f32 v74, v74, v80
    v_mul_f32 v75, v75, v80
    v_mul_f32 v76, v76, v80
    v_mul_f32 v77, v77, v80
    v_mul_f32 v78, v78, v80
    v_mul_f32_e64 v79, v79, v80
    v_cvt_pk_bf16_f32 v212, v64, v65
    v_cvt_pk_bf16_f32 v213, v66, v67
    v_cvt_pk_bf16_f32 v216, v68, v69
    v_cvt_pk_bf16_f32 v217, v70, v71
    v_cvt_pk_bf16_f32 v220, v72, v73
    v_cvt_pk_bf16_f32 v221, v74, v75
    v_cvt_pk_bf16_f32 v224, v76, v77
    v_cvt_pk_bf16_f32 v225, v78, v79
    v_mul_f32 v48, v48, v84
    v_mul_f32 v49, v49, v84
    v_mul_f32 v50, v50, v84
    v_mul_f32 v51, v51, v84
    v_mul_f32 v52, v52, v84
    v_mul_f32 v53, v53, v84
    v_mul_f32 v54, v54, v84
    v_mul_f32 v55, v55, v84
    v_mul_f32 v56, v56, v84
    v_mul_f32 v57, v57, v84
    v_mul_f32 v58, v58, v84
    v_mul_f32 v59, v59, v84
    v_mul_f32 v60, v60, v84
    v_mul_f32 v61, v61, v84
    v_mul_f32 v62, v62, v84
    v_mul_f32 v63, v63, v84
    v_cvt_pk_bf16_f32 v214, v48, v49
    v_cvt_pk_bf16_f32 v215, v50, v51
    v_cvt_pk_bf16_f32 v218, v52, v53
    v_cvt_pk_bf16_f32 v219, v54, v55
    v_cvt_pk_bf16_f32 v222, v56, v57
    v_cvt_pk_bf16_f32 v223, v58, v59
    v_cvt_pk_bf16_f32 v226, v60, v61
    v_cvt_pk_bf16_f32 v227, v62, v63
    v_permlane32_swap_b32 v212, v220
    v_permlane32_swap_b32 v216, v224
    v_permlane32_swap_b32 v213, v221
    v_permlane32_swap_b32 v217, v225
    v_permlane32_swap_b32 v214, v222
    v_permlane32_swap_b32 v218, v226
    v_permlane32_swap_b32 v215, v223
    v_permlane32_swap_b32 v219, v227
    v_permlane16_swap_b32 v212, v216
    v_permlane16_swap_b32 v220, v224
    v_permlane16_swap_b32 v213, v217
    v_permlane16_swap_b32 v221, v225
    v_permlane16_swap_b32 v214, v218
    v_permlane16_swap_b32 v222, v226
    v_permlane16_swap_b32 v215, v219
    v_permlane16_swap_b32 v223, v227
    s_mov_b32 s3, 0
    s_waitcnt vmcnt(0)
L_sw_12:
    v_max_u32_e64 v2, v91, v95
    v_cmp_eq_u32 vcc, -1, v2
    s_nop 0
    s_cbranch_vccz L_swd_13
    s_add_u32 s3, s3, 1
    s_cmp_gt_u32 s3, 200000
    s_cbranch_scc1 L_swd_13
    buffer_load_dwordx4 v[88:91], v254, s[16:19], s47 offen offset:0 sc1
    buffer_load_dwordx4 v[92:95], v254, s[16:19], s47 offen offset:1024 sc1
    s_waitcnt vmcnt(0)
    s_branch L_sw_12
L_swd_13:
    v_add_f32 v88, v88, v92
    v_add_f32 v89, v89, v93
    v_add_f32 v90, v90, v94
    v_add_f32_e64 v91, v91, v95
    v_add_f32_dpp v88, v88, v88 quad_perm:[2,3,0,1] row_mask:0xf bank_mask:0xf
    v_add_f32_dpp v89, v89, v89 quad_perm:[2,3,0,1] row_mask:0xf bank_mask:0xf
    v_add_f32_dpp v90, v90, v90 quad_perm:[2,3,0,1] row_mask:0xf bank_mask:0xf
    v_add_f32_dpp v91, v91, v91 quad_perm:[2,3,0,1] row_mask:0xf bank_mask:0xf
    v_add_f32_dpp v88, v88, v88 row_ror:4 row_mask:0xf bank_mask:0xf
    v_add_f32_dpp v89, v89, v89 row_ror:4 row_mask:0xf bank_mask:0xf
    v_add_f32_dpp v90, v90, v90 row_ror:4 row_mask:0xf bank_mask:0xf
    v_add_f32_dpp v91, v91, v91 row_ror:4 row_mask:0xf bank_mask:0xf
    v_add_f32_dpp v88, v88, v88 row_ror:8 row_mask:0xf bank_mask:0xf
    v_add_f32_dpp v89, v89, v89 row_ror:8 row_mask:0xf bank_mask:0xf
    v_add_f32_dpp v90, v90, v90 row_ror:8 row_mask:0xf bank_mask:0xf
    v_add_f32_dpp v91, v91, v91 row_ror:8 row_mask:0xf bank_mask:0xf
    v_cvt_pk_bf16_f32 v92, v88, v89
    v_cvt_pk_bf16_f32 v93, v90, v91
    s_nop 0
    v_mov_b32_dpp v116, v92 quad_perm:[0,0,2,2] row_mask:0xf bank_mask:0xf
    v_mov_b32_dpp v117, v93 quad_perm:[0,0,2,2] row_mask:0xf bank_mask:0xf
    v_mov_b32_dpp v118, v92 quad_perm:[1,1,3,3] row_mask:0xf bank_mask:0xf
    v_mov_b32_dpp v119, v93 quad_perm:[1,1,3,3] row_mask:0xf bank_mask:0xf
    s_nop 1
    v_mfma_f32_16x16x32_bf16 v[32:35], v[116:119], v[196:199], 0
    v_mfma_f32_16x16x32_bf16 v[36:39], v[116:119], v[200:203], 0
    v_mfma_f32_16x16x32_bf16 v[40:43], v[116:119], v[204:207], 0
    v_mfma_f32_16x16x32_bf16 v[44:47], v[116:119], v[208:211], 0
    v_mfma_f32_16x16x32_bf16 v[48:51], v[116:119], v[212:215], 0
    v_mfma_f32_16x16x32_bf16 v[52:55], v[116:119], v[216:219], 0
    v_mfma_f32_16x16x32_bf16 v[56:59], v[116:119], v[220:223], 0
    v_mfma_f32_16x16x32_bf16 v[60:63], v[116:119], v[224:227], 0
    s_nop 0
    v_add_f32 v32, 0x358637bd, v32
    v_add_f32 v36, 0x358637bd, v36
    v_add_f32 v40, 0x358637bd, v40
    v_add_f32 v44, 0x358637bd, v44
    v_add_f32 v48, 0x358637bd, v48
    v_add_f32 v52, 0x358637bd, v52
    v_add_f32 v56, 0x358637bd, v56
    v_add_f32 v60, 0x358637bd, v60
    v_rcp_f32 v32, v32
    v_rcp_f32 v36, v36
    v_rcp_f32 v40, v40
    v_rcp_f32 v44, v44
    v_rcp_f32 v48, v48
    v_rcp_f32 v52, v52
    v_rcp_f32 v56, v56
    v_rcp_f32_e64 v60, v60
    buffer_load_dwordx4 v[96:99], v251, s[16:19], s48 offen sc1
    s_mov_b32 s3, 0
    s_waitcnt vmcnt(0)
L_sw_14:
    v_cmp_eq_u32 vcc, -1, v99
    s_nop 0
    s_cbranch_vccz L_swd_15
    s_add_u32 s3, s3, 1
    s_cmp_gt_u32 s3, 200000
    s_cbranch_scc1 L_swd_15
    buffer_load_dwordx4 v[96:99], v251, s[16:19], s48 offen sc1
    s_waitcnt vmcnt(0)
    s_branch L_sw_14
L_swd_15:
    v_mfma_f32_16x16x32_bf16 v[64:67], v[96:99], v[196:199], 0
    v_mfma_f32_16x16x32_bf16 v[68:71], v[96:99], v[200:203], 0
    v_mfma_f32_16x16x32_bf16 v[72:75], v[96:99], v[204:207], 0
    v_mfma_f32_16x16x32_bf16 v[76:79], v[96:99], v[208:211], 0
    v_mfma_f32_16x16x32_bf16 v[80:83], v[96:99], v[212:215], 0
    v_mfma_f32_16x16x32_bf16 v[84:87], v[96:99], v[216:219], 0
    v_mfma_f32_16x16x32_bf16 v[88:91], v[96:99], v[220:223], 0
    v_mfma_f32_16x16x32_bf16 v[92:95], v[96:99], v[224:227], 0
    s_nop 0
    v_mul_f32 v64, v64, v32
    v_mul_f32 v65, v65, v32
    v_mul_f32 v66, v66, v32
    v_mul_f32 v67, v67, v32
    v_cvt_pk_bf16_f32 v100, v64, v65
    v_cvt_pk_bf16_f32 v101, v66, v67
    v_mul_f32 v68, v68, v36
    v_mul_f32 v69, v69, v36
    v_mul_f32 v70, v70, v36
    v_mul_f32 v71, v71, v36
    v_cvt_pk_bf16_f32 v102, v68, v69
    v_cvt_pk_bf16_f32 v103, v70, v71
    s_nop 0
    v_permlane16_swap_b32 v100, v102
    v_permlane16_swap_b32 v101, v103
    buffer_store_dwordx4 v[100:103], v233, s[16:19], s72 offen offset:0 sc1
    v_mul_f32 v72, v72, v40
    v_mul_f32 v73, v73, v40
    v_mul_f32 v74, v74, v40
    v_mul_f32_e64 v75, v75, v40
    v_cvt_pk_bf16_f32 v104, v72, v73
    v_cvt_pk_bf16_f32 v105, v74, v75
    v_mul_f32 v76, v76, v44
    v_mul_f32 v77, v77, v44
    v_mul_f32 v78, v78, v44
    v_mul_f32 v79, v79, v44
    v_cvt_pk_bf16_f32 v106, v76, v77
    v_cvt_pk_bf16_f32 v107, v78, v79
    s_nop 0
    v_permlane16_swap_b32 v104, v106
    v_permlane16_swap_b32 v105, v107
    buffer_store_dwordx4 v[104:107], v233, s[16:19], s72 offen offset:2048 sc1
    v_mul_f32 v80, v80, v48
    v_mul_f32 v81, v81, v48
    v_mul_f32 v82, v82, v48
    v_mul_f32_e64 v83, v83, v48
    v_cvt_pk_bf16_f32 v108, v80, v81
    v_cvt_pk_bf16_f32 v109, v82, v83
    v_mul_f32 v84, v84, v52
    v_mul_f32 v85, v85, v52
    v_mul_f32 v86, v86, v52
    v_mul_f32 v87, v87, v52
    v_cvt_pk_bf16_f32 v110, v84, v85
    v_cvt_pk_bf16_f32 v111, v86, v87
    s_nop 0
    v_permlane16_swap_b32 v108, v110
    v_permlane16_swap_b32 v109, v111
    buffer_store_dwordx4 v[108:111], v233, s[16:19], s73 offen offset:0 sc1
    v_mul_f32 v88, v88, v56
    v_mul_f32 v89, v89, v56
    v_mul_f32 v90, v90, v56
    v_mul_f32_e64 v91, v91, v56
    v_cvt_pk_bf16_f32 v112, v88, v89
    v_cvt_pk_bf16_f32 v113, v90, v91
    v_mul_f32 v92, v92, v60
    v_mul_f32 v93, v93, v60
    v_mul_f32 v94, v94, v60
    v_mul_f32 v95, v95, v60
    v_cvt_pk_bf16_f32 v114, v92, v93
    v_cvt_pk_bf16_f32 v115, v94, v95
    s_nop 0
    v_permlane16_swap_b32 v112, v114
    v_permlane16_swap_b32 v113, v115
    buffer_store_dwordx4 v[112:115], v233, s[16:19], s73 offen offset:2048 sc1
L_Hfin:
    s_mov_b64 exec, 0xff
    s_mov_b32 s7, 0
L_poll_16:
    buffer_load_dword v235, v232, s[16:19], s70 offen offset:0 sc1
    s_add_u32 s7, s7, 1
    s_cmp_gt_u32 s7, 200000
    s_cbranch_scc1 L_polld_17
    s_waitcnt vmcnt(0)
    v_cmp_ne_u32 vcc, s68, v235
    s_nop 0
    s_cbranch_vccz L_polld_17
    s_sleep 6
    s_branch L_poll_16
L_polld_17:
    s_waitcnt vmcnt(0)
    s_mov_b64 exec, -1
    s_barrier
    v_lshlrev_b32 v4, 16, v240
    v_and_b32 v5, 0xffff0000, v240
    v_lshlrev_b32_e64 v12, 16, v244
    v_and_b32 v13, 0xffff0000, v244
    v_lshlrev_b32_e64 v6, 16, v241
    v_and_b32 v7, 0xffff0000, v241
    v_lshlrev_b32_e64 v14, 16, v245
    v_and_b32 v15, 0xffff0000, v245
    v_lshlrev_b32_e64 v8, 16, v242
    v_and_b32 v9, 0xffff0000, v242
    v_lshlrev_b32_e64 v16, 16, v246
    v_and_b32 v17, 0xffff0000, v246
    v_lshlrev_b32_e64 v10, 16, v243
    v_and_b32 v11, 0xffff0000, v243
    v_lshlrev_b32_e64 v18, 16, v247
    v_and_b32 v19, 0xffff0000, v247
    v_add_f32 v240, v4, v12
    v_add_f32 v241, v5, v13
    v_add_f32 v242, v6, v14
    v_add_f32 v243, v7, v15
    v_add_f32 v244, v8, v16
    v_add_f32 v245, v9, v17
    v_add_f32 v246, v10, v18
    v_add_f32_e64 v247, v11, v19
    s_barrier
    ds_read_b128 v[104:107], v255 offset:0
    ds_read_b128 v[108:111], v255 offset:16
    ds_read_b128 v[112:115], v255 offset:4096
    ds_read_b128 v[116:119], v255 offset:4112
    ds_read_b128 v[120:123], v255 offset:8192
    ds_read_b128 v[124:127], v255 offset:8208
    ds_read_b128 v[128:131], v255 offset:12288
    ds_read_b128 v[132:135], v255 offset:12304
    s_waitcnt lgkmcnt(6)
    v_add_f32 v240, v240, v104
    v_add_f32 v241, v241, v105
    v_add_f32 v242, v242, v106
    v_add_f32 v243, v243, v107
    v_add_f32 v244, v244, v108
    v_add_f32 v245, v245, v109
    v_add_f32 v246, v246, v110
    v_add_f32 v247, v247, v111
    s_waitcnt lgkmcnt(4)
    v_add_f32 v240, v240, v112
    v_add_f32 v241, v241, v113
    v_add_f32 v242, v242, v114
    v_add_f32 v243, v243, v115
    v_add_f32 v244, v244, v116
    v_add_f32 v245, v245, v117
    v_add_f32 v246, v246, v118
    v_add_f32 v247, v247, v119
    s_waitcnt lgkmcnt(2)
    v_add_f32 v240, v240, v120
    v_add_f32 v241, v241, v121
    v_add_f32 v242, v242, v122
    v_add_f32 v243, v243, v123
    v_add_f32 v244, v244, v124
    v_add_f32 v245, v245, v125
    v_add_f32 v246, v246, v126
    v_add_f32 v247, v247, v127
    s_waitcnt lgkmcnt(0)
    v_add_f32 v240, v240, v128
    v_add_f32 v241, v241, v129
    v_add_f32 v242, v242, v130
    v_add_f32 v243, v243, v131
    v_add_f32 v244, v244, v132
    v_add_f32 v245, v245, v133
    v_add_f32 v246, v246, v134
    v_add_f32 v247, v247, v135
    v_cvt_pk_bf16_f32 v16, v240, v241
    v_cvt_pk_bf16_f32 v17, v242, v243
    v_cvt_pk_bf16_f32 v18, v244, v245
    v_cvt_pk_bf16_f32 v19, v246, v247
    buffer_store_dwordx4 v[16:19], v248, s[28:31], 0 offen sc1
    s_barrier
    s_or_b32 s5, s2, s66
    s_cmp_eq_u32 s5, 0
    s_cbranch_scc0 L_done
    s_mov_b32 s5, 0
    s_mov_b64 exec, 1
    buffer_store_dword v1, v251, s[16:19], s5 offen offset:0 sc1
    s_mov_b64 exec, -1
    s_branch L_done
L_C:
    s_load_dwordx2 s[36:37], s[0:1], 64
    s_load_dwordx2 s[28:29], s[0:1], 72
    s_and_b32 s67, s66, 3
    s_setprio 2
    s_and_b32 s7, s2, 6
    s_lshr_b32 s65, s2, 6
    s_lshl1_add_u32 s60, s7, s65
    s_bfe_u32 s61, s2, 0x30003
    s_and_b32 s64, s2, 1
    s_lshl3_add_u32 s75, s64, s61
    v_and_b32 v17, 31, v0
    v_lshrrev_b32 v30, 5, v0
    v_lshlrev_b32 v17, 4, v17
    v_lshl_add_u32 v17, v30, 10, v17
    v_mov_b32_e64 v18, 0
    s_lshl_b32 s3, s60, 7
    s_lshl_b32 s5, s75, 3
    s_add_u32 s3, s3, s5
    s_lshl_b32 s5, s67, 1
    s_add_u32 s3, s3, s5
    s_lshl_b32 s5, s3, 10
    s_mov_b32 s10, 2097152
    s_mov_b32 s11, 0x20000
    s_waitcnt lgkmcnt(0)
    s_mov_b32 s8, s40
    s_and_b32 s9, s41, 0xffff
    buffer_load_dwordx4 v[64:67], v17, s[8:11], s5 offen
    buffer_load_dwordx4 v[68:71], v17, s[8:11], s5 offen offset:512
    s_mov_b32 s18, 268435456
    s_mov_b32 s19, 0x20000
    buffer_load_dword v31, v18, s[16:19], 0 offen sc1
    s_setprio 0
    s_lshl_b32 s43, s3, 4
    s_add_u32 s43, s43, 65536
    s_lshr_b32 s40, s67, 1
    s_and_b32 s41, s67, 1
    s_lshl_b32 s42, s67, 12
    v_and_b32 v14, 15, v0
    v_lshrrev_b32 v15, 4, v0
    v_lshrrev_b32 v2, 1, v14
    v_xor_b32 v2, v2, v15
    v_lshlrev_b32 v2, 4, v2
    v_lshl_add_u32 v2, v14, 7, v2
    s_lshl_b32 s5, s40, 13
    v_add_u32 v2, s5, v2
    v_xor_b32_e64 v3, 64, v2
    v_bfe_u32 v24, v0, 2, 2
    v_and_b32_e64 v25, 3, v0
    v_lshl_add_u32 v26, v15, 3, v24
    v_lshlrev_b32_e64 v26, 7, v26
    v_lshl_add_u32 v26, v25, 3, v26
    v_bfe_u32 v27, v0, 3, 2
    v_lshl_add_u32 v26, v27, 5, v26
    s_lshl_b32 s5, s41, 6
    v_xor_b32 v4, s5, v26
    v_add_u32 v4, 16384, v4
    v_xor_b32 v5, 32, v4
    v_mov_b32 v6, v2
    v_mov_b32 v7, v3
    v_mov_b32 v8, v4
    v_mov_b32 v9, v5
    v_add_u32_e64 v236, s42, v26
    s_and_b32 s61, s61, 7
    s_and_b32 s64, s2, 1
    s_and_b32 s62, s61, 1
    s_and_b32 s67, s66, 3
    s_lshr_b32 s63, s61, 1
    s_lshl2_add_u32 s63, s64, s63
    s_add_u32 s6, s63, 1
    s_lshr_b32 s6, s6, 1
    s_min_u32 s6, s6, 3
    s_mul_i32 s77, s63, 5
    s_add_u32 s77, s77, s6
    s_lshr_b32 s78, 0x15, s63
    s_and_b32 s78, s78, 1
    s_lshl_b32 s74, s60, 1
    s_add_u32 s74, s74, s64
    s_lshl_b32 s75, s64, 3
    s_add_u32 s75, s75, s61
    s_lshl_b32 s76, s62, 3
    s_add_u32 s76, s76, s63
    s_and_b32 s79, s65, 3
    s_mov_b64 s[20:21], s[54:55]
    s_mov_b32 s22, 1409024
    s_mov_b32 s23, 0x20000
    s_mov_b64 s[24:25], s[46:47]
    s_mov_b32 s26, 524288
    s_mov_b32 s27, 0x20000
    s_mov_b32 s30, 2097152
    s_mov_b32 s31, 0x20000
    s_mov_b32 s38, 1024
    s_mov_b32 s39, 0x20000
    v_xor_b32 v237, 32, v236
    v_xor_b32_e64 v238, 64, v236
    v_xor_b32 v239, 96, v236
    v_lshlrev_b32 v192, 4, v14
    s_lshl_b32 s5, s41, 9
    s_add_u32 s5, s5, 147456
    v_add_u32 v11, s5, v192
    s_lshl_b32 s5, s40, 10
    s_add_u32 s5, s5, 151552
    v_mov_b32_e64 v193, s5
    v_mov_b32 v194, 150528
    v_cmp_eq_u32 vcc, 0, v15
    s_nop 1
    v_cndmask_b32 v193, v194, v193, vcc
    v_add_u32_e64 v10, v192, v193
    s_lshl_b32 s5, s40, 9
    s_add_u32 s5, s5, 153600
    v_lshl_add_u32 v12, v14, 3, s5
    v_and_b32_e64 v192, 31, v0
    v_lshl_add_u32 v13, v192, 3, s5
    s_lshl_b32 s5, s40, 14
    s_lshl_b32 s6, s41, 13
    s_add_u32 s5, s5, s6
    s_add_u32 s5, s5, 32768
    v_bfe_u32 v193, v192, 1, 2
    v_lshlrev_b32 v193, 4, v193
    v_lshl_add_u32 v193, v192, 6, v193
    v_lshrrev_b32_e64 v194, 5, v0
    v_lshl_add_u32 v193, v194, 12, v193
    v_add_u32_e64 v252, s5, v193
    s_lshl_b32 s5, s40, 11
    s_add_u32 s5, s5, s6
    s_add_u32 s6, s5, 147456
    s_add_u32 s5, s5, 65536
    v_lshrrev_b32 v193, 2, v14
    v_xor_b32 v194, v193, v15
    v_lshlrev_b32_e64 v194, 3, v194
    v_lshl_add_u32 v194, v14, 5, v194
    v_add_u32 v253, s5, v194
    v_and_b32 v193, 2, v193
    v_xor_b32 v194, v193, v15
    v_lshlrev_b32 v194, 3, v194
    v_lshl_add_u32 v194, v14, 5, v194
    v_add_u32 v254, s6, v194
    v_lshrrev_b32 v192, 5, v0
    v_bfe_u32 v193, v0, 2, 2
    v_lshl_add_u32 v192, v192, 3, v193
    v_lshlrev_b32_e64 v250, 5, v192
    v_bfe_u32 v192, v0, 4, 1
    v_bfe_u32 v193, v0, 1, 1
    v_lshl_add_u32 v192, v192, 1, v193
    v_lshl_add_u32 v250, v192, 3, v250
    v_and_b32_e64 v192, 1, v0
    v_lshl_add_u32 v250, v192, 9, v250
    s_and_b32 s5, s67, 1
    s_lshl_b32 s5, s5, 10
    s_and_b32 s6, s63, 1
    s_lshl_b32 s6, s6, 11
    s_add_u32 s5, s5, s6
    s_add_u32 s5, s5, 154624
    v_add_u32 v250, s5, v250
    v_lshrrev_b32 v192, 3, v0
    v_and_b32 v193, 7, v0
    v_and_b32 v194, 2, v192
    v_xor_b32 v193, v193, v194
    v_lshlrev_b32 v193, 4, v193
    v_lshrrev_b32 v194, 2, v192
    v_and_b32_e64 v195, 3, v192
    v_lshl_add_u32 v194, v194, 4, v195
    v_lshl_add_u32 v224, v194, 10, v193
    v_lshl_add_u32 v228, v192, 10, v193
    v_xor_b32_e64 v225, 64, v224
    v_add_u32 v225, 3072, v225
    v_xor_b32_e64 v229, 64, v228
    v_add_u32 v229, 7168, v229
    v_add_u32 v226, 6144, v224
    v_add_u32 v230, 14336, v228
    v_xor_b32_e64 v227, 64, v224
    v_add_u32 v227, 9216, v227
    v_xor_b32_e64 v231, 64, v228
    v_add_u32 v231, 21504, v231
    s_mul_i32 s44, s67, 11
    s_cmp_eq_u32 s67, 3
    s_cselect_b32 s5, 5, 6
    s_add_u32 s45, s44, s5
    s_lshl_b32 s51, s61, 7
    s_xor_b32 s5, s79, 0
    s_and_b32 s6, s5, 1
    s_cmp_ge_u32 s5, 2
    s_cselect_b32 s5, s45, s44
    s_add_u32 s56, s5, s6
    s_xor_b32 s5, s79, 1
    s_and_b32 s6, s5, 1
    s_cmp_ge_u32 s5, 2
    s_cselect_b32 s5, s45, s44
    s_add_u32 s57, s5, s6
    s_xor_b32 s5, s79, 2
    s_and_b32 s6, s5, 1
    s_cmp_ge_u32 s5, 2
    s_cselect_b32 s5, s45, s44
    s_add_u32 s58, s5, s6
    s_xor_b32 s5, s79, 3
    s_and_b32 s6, s5, 1
    s_cmp_ge_u32 s5, 2
    s_cselect_b32 s5, s45, s44
    s_add_u32 s59, s5, s6
    v_lshrrev_b32 v192, 3, v0
    v_and_b32 v193, 7, v0
    v_lshlrev_b32 v249, 4, v193
    v_lshl_add_u32 v248, v192, 10, v249
    s_lshl_b32 s5, s74, 16
    s_lshl_b32 s6, s66, 13
    s_add_u32 s5, s5, s6
    s_add_u32 s5, s5, s51
    v_add_u32 v248, s5, v248
    s_lshr_b32 s5, s66, 1
    s_lshl_b32 s5, s5, 15
    s_and_b32 s6, s66, 1
    s_lshl_b32 s6, s6, 7
    s_add_u32 s5, s5, s6
    v_lshrrev_b32_e64 v192, 5, v0
    v_lshl_add_u32 v255, v192, 6, s5
    v_bfe_u32 v192, v0, 0, 1
    v_mul_u32_u24 v192, 32, v192
    v_add_u32 v255, v255, v192
    v_bfe_u32 v192, v0, 1, 1
    v_mul_u32_u24 v192, 272, v192
    v_add_u32_e64 v255, v255, v192
    v_bfe_u32 v192, v0, 2, 1
    v_mul_u32_u24 v192, 768, v192
    v_add_u32_e64 v255, v255, v192
    v_bfe_u32 v192, v0, 3, 1
    v_mul_u32_u24 v192, 1344, v192
    v_add_u32_e64 v255, v255, v192
    v_bfe_u32 v192, v0, 4, 1
    v_mul_u32_u24 v192, 16512, v192
    v_add_u32 v255, v255, v192
    v_lshlrev_b32 v232, 7, v0
    s_mul_i32 s46, s74, 245760
    s_add_u32 s46, s46, 2097152
    s_lshl_b32 s3, s60, 1
    s_add_u32 s3, s3, s40
    s_mul_i32 s47, s3, 245760
    s_add_u32 s5, s77, s41
    s_lshl_b32 s5, s5, 12
    s_add_u32 s47, s47, s5
    s_add_u32 s47, s47, 2097152
    s_lshl_b32 s50, s3, 13
    s_lshl_b32 s5, s63, 8
    s_add_u32 s50, s50, s5
    s_lshl_b32 s5, s41, 7
    s_add_u32 s50, s50, s5
    s_add_u32 s50, s50, 1310720
    s_lshl_b32 s49, s74, 13
    s_lshl_b32 s5, s67, 9
    s_add_u32 s49, s49, s5
    s_add_u32 s49, s49, 1310720
    s_lshl_b32 s70, s74, 12
    s_lshl_b32 s5, s67, 10
    s_add_u32 s70, s70, s5
    s_add_u32 s70, s70, 1572864
    v_lshlrev_b32 v14, 2, v0
    v_lshlrev_b32 v251, 4, v0
    s_waitcnt vmcnt(0)
    s_setprio 2
    v_readfirstlane_b32 s68, v31
    v_lshlrev_b32 v32, 16, v64
    v_and_b32 v33, 0xffff0000, v64
    v_lshlrev_b32_e64 v34, 16, v65
    v_and_b32 v35, 0xffff0000, v65
    v_lshlrev_b32_e64 v36, 16, v66
    v_and_b32 v37, 0xffff0000, v66
    v_lshlrev_b32_e64 v38, 16, v67
    v_and_b32 v39, 0xffff0000, v67
    v_lshlrev_b32_e64 v40, 16, v68
    v_and_b32 v41, 0xffff0000, v68
    v_lshlrev_b32_e64 v42, 16, v69
    v_and_b32 v43, 0xffff0000, v69
    v_lshlrev_b32_e64 v44, 16, v70
    v_and_b32 v45, 0xffff0000, v70
    v_lshlrev_b32_e64 v46, 16, v71
    v_and_b32 v47, 0xffff0000, v71
    s_mul_i32 s68, s68, 0x9E3779B1
    s_add_u32 s68, s68, 0x7F4A7C15
    v_pk_add_f32 v[48:49], v[32:33], v[34:35]
    v_pk_add_f32 v[50:51], v[36:37], v[38:39]
    v_pk_add_f32 v[52:53], v[40:41], v[42:43]
    v_pk_add_f32 v[54:55], v[44:45], v[46:47]
    v_pk_add_f32 v[48:49], v[48:49], v[50:51]
    v_pk_add_f32 v[52:53], v[52:53], v[54:55]
    v_pk_add_f32 v[48:49], v[48:49], v[52:53]
    v_add_f32 v60, v48, v49
    s_nop 1
    v_add_f32_dpp v60, v60, v60 quad_perm:[1,0,3,2] row_mask:0xf bank_mask:0xf
    s_nop 1
    v_add_f32_dpp v60, v60, v60 quad_perm:[2,3,0,1] row_mask:0xf bank_mask:0xf
    s_nop 1
    v_add_f32_dpp v60, v60, v60 row_half_mirror row_mask:0xf bank_mask:0xf
    s_nop 1
    v_add_f32_dpp v60, v60, v60 row_mirror row_mask:0xf bank_mask:0xf
    v_mov_b32 v48, v60
    s_nop 1
    v_permlane16_swap_b32 v60, v48
    v_add_f32_e64 v60, v60, v48
    v_mul_f32 v60, 0xbb000000, v60
    v_pk_add_f32 v[32:33], v[32:33], v[60:61] op_sel_hi:[1,0]
    v_pk_add_f32 v[34:35], v[34:35], v[60:61] op_sel_hi:[1,0]
    v_pk_add_f32 v[36:37], v[36:37], v[60:61] op_sel_hi:[1,0]
    v_pk_add_f32 v[38:39], v[38:39], v[60:61] op_sel_hi:[1,0]
    v_pk_add_f32 v[40:41], v[40:41], v[60:61] op_sel_hi:[1,0]
    v_pk_add_f32 v[42:43], v[42:43], v[60:61] op_sel_hi:[1,0]
    v_pk_add_f32 v[44:45], v[44:45], v[60:61] op_sel_hi:[1,0]
    v_pk_add_f32 v[46:47], v[46:47], v[60:61] op_sel_hi:[1,0]
    v_pk_mul_f32 v[48:49], v[32:33], v[32:33]
    v_pk_mul_f32 v[50:51], v[34:35], v[34:35]
    v_pk_fma_f32 v[48:49], v[36:37], v[36:37], v[48:49]
    v_pk_fma_f32 v[50:51], v[38:39], v[38:39], v[50:51]
    v_pk_fma_f32 v[48:49], v[40:41], v[40:41], v[48:49]
    v_pk_fma_f32 v[50:51], v[42:43], v[42:43], v[50:51]
    v_pk_fma_f32 v[48:49], v[44:45], v[44:45], v[48:49]
    v_pk_fma_f32 v[50:51], v[46:47], v[46:47], v[50:51]
    v_pk_add_f32 v[48:49], v[48:49], v[50:51]
    v_add_f32 v61, v48, v49
    s_nop 1
    v_add_f32_dpp v61, v61, v61 quad_perm:[1,0,3,2] row_mask:0xf bank_mask:0xf
    s_nop 1
    v_add_f32_dpp v61, v61, v61 quad_perm:[2,3,0,1] row_mask:0xf bank_mask:0xf
    s_nop 1
    v_add_f32_dpp v61, v61, v61 row_half_mirror row_mask:0xf bank_mask:0xf
    s_nop 1
    v_add_f32_dpp v61, v61, v61 row_mirror row_mask:0xf bank_mask:0xf
    v_mov_b32 v48, v61
    s_nop 1
    v_permlane16_swap_b32 v61, v48
    v_add_f32_e64 v61, v61, v48
    v_mov_b32 v48, 0x3727c5ac
    v_fmac_f32 v48, 0x3b000000, v61
    v_sqrt_f32 v61, v48
    v_mov_b32 v59, s68
    v_rcp_f32 v58, v61
    v_mov_b32 v1, s68
    v_cvt_pk_bf16_f32 v48, v60, v61
    v_lshlrev_b32_e64 v50, 16, v48
    v_and_b32 v51, 0xffff0000, v48
    v_pk_add_f32 v[50:51], v[60:61], v[50:51] neg_lo:[0,1] neg_hi:[0,1]
    v_cvt_pk_bf16_f32 v56, v60, v50
    v_cvt_pk_bf16_f32 v57, v61, v51
    v_lshlrev_b32_e64 v30, 4, v30
    s_mov_b32 exec_lo, 1
    s_mov_b32 exec_hi, 1
    buffer_store_dwordx4 v[56:59], v30, s[16:19], s43 offen sc1
    s_mov_b64 exec, -1
    s_barrier
    ds_read_b64_tr_b16 v[16:17], v8 offset:0
    ds_read_b64_tr_b16 v[18:19], v8 offset:512
    ds_read_b64_tr_b16 v[20:21], v8 offset:4096
    ds_read_b64_tr_b16 v[22:23], v8 offset:4608
    ds_read_b128 v[64:67], v6 offset:0
    ds_read_b128 v[68:71], v7 offset:0
    ds_read_b64_tr_b16 v[24:25], v9 offset:0
    ds_read_b64_tr_b16 v[26:27], v9 offset:512
    ds_read_b128 v[72:75], v6 offset:2048
    ds_read_b128 v[76:79], v7 offset:2048
    ds_read_b64_tr_b16 v[28:29], v9 offset:4096
    ds_read_b64_tr_b16 v[30:31], v9 offset:4608
    ds_read_b128 v[80:83], v6 offset:4096
    ds_read_b128 v[84:87], v7 offset:4096
    s_waitcnt lgkmcnt(2)
    v_mfma_f32_16x16x32_bf16 v[96:99], v[16:19], v[64:67], 0
    ds_read_b128 v[88:91], v6 offset:6144
    v_mfma_f32_16x16x32_bf16 v[96:99], v[20:23], v[68:71], v[96:99]
    ds_read_b128 v[92:95], v7 offset:6144
    v_mfma_f32_16x16x32_bf16 v[112:115], v[24:27], v[64:67], 0
    ds_read_b64_tr_b16 v[32:33], v8 offset:8192
    v_mfma_f32_16x16x32_bf16 v[112:115], v[28:31], v[68:71], v[112:115]
    ds_read_b64_tr_b16 v[34:35], v8 offset:8704
    v_mfma_f32_16x16x32_bf16 v[100:103], v[16:19], v[72:75], 0
    ds_read_b64_tr_b16 v[36:37], v8 offset:12288
    v_mfma_f32_16x16x32_bf16 v[100:103], v[20:23], v[76:79], v[100:103]
    ds_read_b64_tr_b16 v[38:39], v8 offset:12800
    v_mfma_f32_16x16x32_bf16 v[116:119], v[24:27], v[72:75], 0
    ds_read_b64_tr_b16 v[40:41], v9 offset:8192
    v_mfma_f32_16x16x32_bf16 v[116:119], v[28:31], v[76:79], v[116:119]
    ds_read_b64_tr_b16 v[42:43], v9 offset:8704
    s_waitcnt lgkmcnt(8)
    v_mfma_f32_16x16x32_bf16 v[104:107], v[16:19], v[80:83], 0
    ds_read_b64_tr_b16 v[44:45], v9 offset:12288
    v_mfma_f32_16x16x32_bf16 v[104:107], v[20:23], v[84:87], v[104:107]
    ds_read_b64_tr_b16 v[46:47], v9 offset:12800
    v_mfma_f32_16x16x32_bf16 v[120:123], v[24:27], v[80:83], 0
    v_mfma_f32_16x16x32_bf16 v[120:123], v[28:31], v[84:87], v[120:123]
    s_waitcnt lgkmcnt(8)
    v_mfma_f32_16x16x32_bf16 v[108:111], v[16:19], v[88:91], 0
    v_mfma_f32_16x16x32_bf16 v[108:111], v[20:23], v[92:95], v[108:111]
    v_mfma_f32_16x16x32_bf16 v[124:127], v[24:27], v[88:91], 0
    v_mfma_f32_16x16x32_bf16 v[124:127], v[28:31], v[92:95], v[124:127]
    s_waitcnt lgkmcnt(0)
    v_mfma_f32_16x16x32_bf16 v[128:131], v[32:35], v[64:67], 0
    ds_read_b64_tr_b16 v[48:49], v8 offset:16384
    v_mfma_f32_16x16x32_bf16 v[128:131], v[36:39], v[68:71], v[128:131]
    ds_read_b64_tr_b16 v[50:51], v8 offset:16896
    v_mfma_f32_16x16x32_bf16 v[144:147], v[40:43], v[64:67], 0
    ds_read_b64_tr_b16 v[52:53], v8 offset:20480
    v_mfma_f32_16x16x32_bf16 v[144:147], v[44:47], v[68:71], v[144:147]
    ds_read_b64_tr_b16 v[54:55], v8 offset:20992
    v_mfma_f32_16x16x32_bf16 v[132:135], v[32:35], v[72:75], 0
    ds_read_b64_tr_b16 v[56:57], v9 offset:16384
    v_mfma_f32_16x16x32_bf16 v[132:135], v[36:39], v[76:79], v[132:135]
    ds_read_b64_tr_b16 v[58:59], v9 offset:16896
    v_mfma_f32_16x16x32_bf16 v[148:151], v[40:43], v[72:75], 0
    ds_read_b64_tr_b16 v[60:61], v9 offset:20480
    v_mfma_f32_16x16x32_bf16 v[148:151], v[44:47], v[76:79], v[148:151]
    ds_read_b64_tr_b16 v[62:63], v9 offset:20992
    v_mfma_f32_16x16x32_bf16 v[136:139], v[32:35], v[80:83], 0
    v_add_u32 v6, 40960, v2
    v_mfma_f32_16x16x32_bf16 v[136:139], v[36:39], v[84:87], v[136:139]
    v_add_u32 v7, 40960, v3
    v_mfma_f32_16x16x32_bf16 v[152:155], v[40:43], v[80:83], 0
    v_add_u32 v8, 40960, v4
    v_mfma_f32_16x16x32_bf16 v[152:155], v[44:47], v[84:87], v[152:155]
    v_add_u32 v9, 40960, v5
    v_mfma_f32_16x16x32_bf16 v[140:143], v[32:35], v[88:91], 0
    v_mfma_f32_16x16x32_bf16 v[140:143], v[36:39], v[92:95], v[140:143]
    v_mfma_f32_16x16x32_bf16 v[156:159], v[40:43], v[88:91], 0
    v_mfma_f32_16x16x32_bf16 v[156:159], v[44:47], v[92:95], v[156:159]
    s_waitcnt lgkmcnt(0)
    s_barrier
    v_mfma_f32_16x16x32_bf16 v[160:163], v[48:51], v[64:67], 0
    ds_read_b64_tr_b16 v[16:17], v8 offset:0
    s_mov_b32 s52, 40960
    v_mfma_f32_16x16x32_bf16 v[160:163], v[52:55], v[68:71], v[160:163]
    ds_read_b64_tr_b16 v[18:19], v8 offset:512
    s_mov_b32 s53, 1
    v_mfma_f32_16x16x32_bf16 v[176:179], v[56:59], v[64:67], 0
    ds_read_b64_tr_b16 v[20:21], v8 offset:4096
    v_mfma_f32_16x16x32_bf16 v[176:179], v[60:63], v[68:71], v[176:179]
    ds_read_b64_tr_b16 v[22:23], v8 offset:4608
    v_mfma_f32_16x16x32_bf16 v[164:167], v[48:51], v[72:75], 0
    ds_read_b128 v[64:67], v6 offset:0
    v_mfma_f32_16x16x32_bf16 v[164:167], v[52:55], v[76:79], v[164:167]
    ds_read_b128 v[68:71], v7 offset:0
    v_mfma_f32_16x16x32_bf16 v[180:183], v[56:59], v[72:75], 0
    ds_read_b64_tr_b16 v[24:25], v9 offset:0
    v_mfma_f32_16x16x32_bf16 v[180:183], v[60:63], v[76:79], v[180:183]
    ds_read_b64_tr_b16 v[26:27], v9 offset:512
    v_mfma_f32_16x16x32_bf16 v[168:171], v[48:51], v[80:83], 0
    ds_read_b128 v[72:75], v6 offset:2048
    v_mfma_f32_16x16x32_bf16 v[168:171], v[52:55], v[84:87], v[168:171]
    ds_read_b128 v[76:79], v7 offset:2048
    v_mfma_f32_16x16x32_bf16 v[184:187], v[56:59], v[80:83], 0
    ds_read_b64_tr_b16 v[28:29], v9 offset:4096
    v_mfma_f32_16x16x32_bf16 v[184:187], v[60:63], v[84:87], v[184:187]
    ds_read_b64_tr_b16 v[30:31], v9 offset:4608
    v_mfma_f32_16x16x32_bf16 v[172:175], v[48:51], v[88:91], 0
    ds_read_b128 v[80:83], v6 offset:4096
    v_mfma_f32_16x16x32_bf16 v[172:175], v[52:55], v[92:95], v[172:175]
    ds_read_b128 v[84:87], v7 offset:4096
    v_mfma_f32_16x16x32_bf16 v[188:191], v[56:59], v[88:91], 0
    v_mfma_f32_16x16x32_bf16 v[188:191], v[60:63], v[92:95], v[188:191]
    s_branch L_g1
L_g1r:
    v_mfma_f32_16x16x32_bf16 v[160:163], v[48:51], v[64:67], v[160:163]
    ds_read_b64_tr_b16 v[16:17], v8 offset:0
    v_mfma_f32_16x16x32_bf16 v[160:163], v[52:55], v[68:71], v[160:163]
    ds_read_b64_tr_b16 v[18:19], v8 offset:512
    v_mfma_f32_16x16x32_bf16 v[176:179], v[56:59], v[64:67], v[176:179]
    ds_read_b64_tr_b16 v[20:21], v8 offset:4096
    v_mfma_f32_16x16x32_bf16 v[176:179], v[60:63], v[68:71], v[176:179]
    ds_read_b64_tr_b16 v[22:23], v8 offset:4608
    v_mfma_f32_16x16x32_bf16 v[164:167], v[48:51], v[72:75], v[164:167]
    ds_read_b128 v[64:67], v6 offset:0
    v_mfma_f32_16x16x32_bf16 v[164:167], v[52:55], v[76:79], v[164:167]
    ds_read_b128 v[68:71], v7 offset:0
    v_mfma_f32_16x16x32_bf16 v[180:183], v[56:59], v[72:75], v[180:183]
    ds_read_b64_tr_b16 v[24:25], v9 offset:0
    v_mfma_f32_16x16x32_bf16 v[180:183], v[60:63], v[76:79], v[180:183]
    ds_read_b64_tr_b16 v[26:27], v9 offset:512
    v_mfma_f32_16x16x32_bf16 v[168:171], v[48:51], v[80:83], v[168:171]
    ds_read_b128 v[72:75], v6 offset:2048
    v_mfma_f32_16x16x32_bf16 v[168:171], v[52:55], v[84:87], v[168:171]
    ds_read_b128 v[76:79], v7 offset:2048
    v_mfma_f32_16x16x32_bf16 v[184:187], v[56:59], v[80:83], v[184:187]
    ds_read_b64_tr_b16 v[28:29], v9 offset:4096
    v_mfma_f32_16x16x32_bf16 v[184:187], v[60:63], v[84:87], v[184:187]
    ds_read_b64_tr_b16 v[30:31], v9 offset:4608
    v_mfma_f32_16x16x32_bf16 v[172:175], v[48:51], v[88:91], v[172:175]
    ds_read_b128 v[80:83], v6 offset:4096
    v_mfma_f32_16x16x32_bf16 v[172:175], v[52:55], v[92:95], v[172:175]
    ds_read_b128 v[84:87], v7 offset:4096
    v_mfma_f32_16x16x32_bf16 v[188:191], v[56:59], v[88:91], v[188:191]
    v_mfma_f32_16x16x32_bf16 v[188:191], v[60:63], v[92:95], v[188:191]
L_g1:
    s_waitcnt lgkmcnt(2)
    v_mfma_f32_16x16x32_bf16 v[96:99], v[16:19], v[64:67], v[96:99]
    ds_read_b128 v[88:91], v6 offset:6144
    v_mfma_f32_16x16x32_bf16 v[96:99], v[20:23], v[68:71], v[96:99]
    ds_read_b128 v[92:95], v7 offset:6144
    v_mfma_f32_16x16x32_bf16 v[112:115], v[24:27], v[64:67], v[112:115]
    ds_read_b64_tr_b16 v[32:33], v8 offset:8192
    v_mfma_f32_16x16x32_bf16 v[112:115], v[28:31], v[68:71], v[112:115]
    ds_read_b64_tr_b16 v[34:35], v8 offset:8704
    v_mfma_f32_16x16x32_bf16 v[100:103], v[16:19], v[72:75], v[100:103]
    ds_read_b64_tr_b16 v[36:37], v8 offset:12288
    v_mfma_f32_16x16x32_bf16 v[100:103], v[20:23], v[76:79], v[100:103]
    ds_read_b64_tr_b16 v[38:39], v8 offset:12800
    v_mfma_f32_16x16x32_bf16 v[116:119], v[24:27], v[72:75], v[116:119]
    ds_read_b64_tr_b16 v[40:41], v9 offset:8192
    v_mfma_f32_16x16x32_bf16 v[116:119], v[28:31], v[76:79], v[116:119]
    ds_read_b64_tr_b16 v[42:43], v9 offset:8704
    s_waitcnt lgkmcnt(8)
    v_mfma_f32_16x16x32_bf16 v[104:107], v[16:19], v[80:83], v[104:107]
    ds_read_b64_tr_b16 v[44:45], v9 offset:12288
    v_mfma_f32_16x16x32_bf16 v[104:107], v[20:23], v[84:87], v[104:107]
    ds_read_b64_tr_b16 v[46:47], v9 offset:12800
    v_mfma_f32_16x16x32_bf16 v[120:123], v[24:27], v[80:83], v[120:123]
    v_mfma_f32_16x16x32_bf16 v[120:123], v[28:31], v[84:87], v[120:123]
    s_waitcnt lgkmcnt(8)
    v_mfma_f32_16x16x32_bf16 v[108:111], v[16:19], v[88:91], v[108:111]
    v_mfma_f32_16x16x32_bf16 v[108:111], v[20:23], v[92:95], v[108:111]
    v_mfma_f32_16x16x32_bf16 v[124:127], v[24:27], v[88:91], v[124:127]
    v_mfma_f32_16x16x32_bf16 v[124:127], v[28:31], v[92:95], v[124:127]
    s_waitcnt lgkmcnt(0)
    v_mfma_f32_16x16x32_bf16 v[128:131], v[32:35], v[64:67], v[128:131]
    ds_read_b64_tr_b16 v[48:49], v8 offset:16384
    v_mfma_f32_16x16x32_bf16 v[128:131], v[36:39], v[68:71], v[128:131]
    ds_read_b64_tr_b16 v[50:51], v8 offset:16896
    v_mfma_f32_16x16x32_bf16 v[144:147], v[40:43], v[64:67], v[144:147]
    ds_read_b64_tr_b16 v[52:53], v8 offset:20480
    v_mfma_f32_16x16x32_bf16 v[144:147], v[44:47], v[68:71], v[144:147]
    ds_read_b64_tr_b16 v[54:55], v8 offset:20992
    v_mfma_f32_16x16x32_bf16 v[132:135], v[32:35], v[72:75], v[132:135]
    ds_read_b64_tr_b16 v[56:57], v9 offset:16384
    v_mfma_f32_16x16x32_bf16 v[132:135], v[36:39], v[76:79], v[132:135]
    ds_read_b64_tr_b16 v[58:59], v9 offset:16896
    v_mfma_f32_16x16x32_bf16 v[148:151], v[40:43], v[72:75], v[148:151]
    ds_read_b64_tr_b16 v[60:61], v9 offset:20480
    v_mfma_f32_16x16x32_bf16 v[148:151], v[44:47], v[76:79], v[148:151]
    ds_read_b64_tr_b16 v[62:63], v9 offset:20992
    v_mfma_f32_16x16x32_bf16 v[136:139], v[32:35], v[80:83], v[136:139]
    s_add_u32 s52, s52, 40960
    s_cmp_eq_u32 s52, 122880
    v_mfma_f32_16x16x32_bf16 v[136:139], v[36:39], v[84:87], v[136:139]
    s_cselect_b32 s52, 0, s52
    s_add_u32 s53, s53, 1
    v_mfma_f32_16x16x32_bf16 v[152:155], v[40:43], v[80:83], v[152:155]
    v_add_u32 v6, s52, v2
    v_add_u32 v7, s52, v3
    v_mfma_f32_16x16x32_bf16 v[152:155], v[44:47], v[84:87], v[152:155]
    v_add_u32 v8, s52, v4
    v_add_u32 v9, s52, v5
    v_mfma_f32_16x16x32_bf16 v[140:143], v[32:35], v[88:91], v[140:143]
    s_cmp_eq_u32 s53, 8
    v_mfma_f32_16x16x32_bf16 v[140:143], v[36:39], v[92:95], v[140:143]
    s_waitcnt lgkmcnt(0)
    v_mfma_f32_16x16x32_bf16 v[156:159], v[40:43], v[88:91], v[156:159]
    s_barrier
    v_mfma_f32_16x16x32_bf16 v[156:159], v[44:47], v[92:95], v[156:159]
    s_cbranch_scc0 L_g1r
L_g1x:
    s_waitcnt vmcnt(0)
    v_mfma_f32_16x16x32_bf16 v[160:163], v[48:51], v[64:67], v[160:163]
    ds_read_b128 v[192:195], v10 offset:0
    v_mfma_f32_16x16x32_bf16 v[160:163], v[52:55], v[68:71], v[160:163]
    ds_read_b128 v[196:199], v10 offset:256
    v_mfma_f32_16x16x32_bf16 v[176:179], v[56:59], v[64:67], v[176:179]
    ds_read_b128 v[200:203], v10 offset:512
    v_mfma_f32_16x16x32_bf16 v[176:179], v[60:63], v[68:71], v[176:179]
    ds_read_b128 v[204:207], v10 offset:768
    v_mfma_f32_16x16x32_bf16 v[164:167], v[48:51], v[72:75], v[164:167]
    ds_read_b128 v[16:19], v11 offset:0
    v_mfma_f32_16x16x32_bf16 v[164:167], v[52:55], v[76:79], v[164:167]
    ds_read_b128 v[20:23], v11 offset:256
    v_mfma_f32_16x16x32_bf16 v[180:183], v[56:59], v[72:75], v[180:183]
    ds_read_b128 v[24:27], v11 offset:1024
    v_mfma_f32_16x16x32_bf16 v[180:183], v[60:63], v[76:79], v[180:183]
    ds_read_b128 v[28:31], v11 offset:1280
    v_mfma_f32_16x16x32_bf16 v[168:171], v[48:51], v[80:83], v[168:171]
    ds_read_b128 v[32:35], v11 offset:2048
    v_mfma_f32_16x16x32_bf16 v[168:171], v[52:55], v[84:87], v[168:171]
    ds_read_b128 v[36:39], v11 offset:2304
    v_mfma_f32_16x16x32_bf16 v[184:187], v[56:59], v[80:83], v[184:187]
    ds_read_b64 v[208:209], v12 offset:0
    v_mfma_f32_16x16x32_bf16 v[184:187], v[60:63], v[84:87], v[184:187]
    ds_read_b64 v[210:211], v12 offset:128
    v_mfma_f32_16x16x32_bf16 v[172:175], v[48:51], v[88:91], v[172:175]
    ds_read_b64 v[212:213], v12 offset:256
    v_mfma_f32_16x16x32_bf16 v[172:175], v[52:55], v[92:95], v[172:175]
    ds_read_b64 v[214:215], v12 offset:384
    v_mfma_f32_16x16x32_bf16 v[188:191], v[56:59], v[88:91], v[188:191]
    v_mfma_f32_16x16x32_bf16 v[188:191], v[60:63], v[92:95], v[188:191]
    s_waitcnt lgkmcnt(4)
    s_cmp_eq_u32 s62, 0
    s_cbranch_scc1 L_Catt
    buffer_load_dwordx4 v[240:243], v248, s[8:11], 0 offen
    buffer_load_dwordx4 v[244:247], v249, s[36:39], s51 offen
    v_mfma_f32_16x16x32_bf16 v[96:99], v[16:19], v[192:195], v[96:99]
    v_mfma_f32_16x16x32_bf16 v[112:115], v[20:23], v[192:195], v[112:115]
    v_mfma_f32_16x16x32_bf16 v[100:103], v[16:19], v[196:199], v[100:103]
    v_mfma_f32_16x16x32_bf16 v[116:119], v[20:23], v[196:199], v[116:119]
    v_mfma_f32_16x16x32_bf16 v[104:107], v[16:19], v[200:203], v[104:107]
    v_mfma_f32_16x16x32_bf16 v[120:123], v[20:23], v[200:203], v[120:123]
    v_mfma_f32_16x16x32_bf16 v[108:111], v[16:19], v[204:207], v[108:111]
    v_mfma_f32_16x16x32_bf16 v[124:127], v[20:23], v[204:207], v[124:127]
    s_waitcnt lgkmcnt(0)
    v_mul_f32 v64, 0xc0135761, v209
    v_mul_f32 v216, v209, v209
    v_mul_f32_e64 v216, v216, v64
    v_mul_f32 v216, 0x3d372713, v216
    v_mul_f32 v66, 0xc0135761, v211
    v_mul_f32 v218, v211, v211
    v_mul_f32 v218, v218, v66
    v_mul_f32 v218, 0x3d372713, v218
    v_mul_f32 v68, 0xc0135761, v213
    v_mul_f32 v220, v213, v213
    v_mul_f32 v220, v220, v68
    v_mul_f32 v220, 0x3d372713, v220
    v_mul_f32 v70, 0xc0135761, v215
    v_mul_f32 v222, v215, v215
    v_mul_f32 v222, v222, v70
    v_mul_f32 v222, 0x3d372713, v222
    v_pk_mul_f32 v[40:41], v[96:97], v[96:97]
    v_pk_mul_f32 v[42:43], v[98:99], v[98:99]
    v_pk_mul_f32 v[44:45], v[112:113], v[112:113]
    v_pk_mul_f32 v[46:47], v[114:115], v[114:115]
    v_pk_fma_f32 v[40:41], v[40:41], v[216:217], v[64:65] op_sel_hi:[1,0,0]
    v_pk_fma_f32 v[42:43], v[42:43], v[216:217], v[64:65] op_sel_hi:[1,0,0]
    v_pk_fma_f32 v[44:45], v[44:45], v[216:217], v[64:65] op_sel_hi:[1,0,0]
    v_pk_fma_f32 v[46:47], v[46:47], v[216:217], v[64:65] op_sel_hi:[1,0,0]
    v_pk_mul_f32 v[40:41], v[40:41], v[96:97]
    v_pk_mul_f32 v[42:43], v[42:43], v[98:99]
    v_pk_mul_f32 v[44:45], v[44:45], v[112:113]
    v_pk_mul_f32 v[46:47], v[46:47], v[114:115]
    v_exp_f32_e64 v40, v40
    v_mfma_f32_16x16x32_bf16 v[128:131], v[24:27], v[192:195], v[128:131]
    v_exp_f32 v41, v41
    v_exp_f32 v42, v42
    v_mfma_f32_16x16x32_bf16 v[144:147], v[28:31], v[192:195], v[144:147]
    v_exp_f32 v43, v43
    v_exp_f32 v44, v44
    v_exp_f32 v45, v45
    v_exp_f32 v46, v46
    v_exp_f32_e64 v47, v47
    v_pk_fma_f32 v[40:41], v[40:41], v[208:209], v[208:209] op_sel_hi:[1,0,0]
    v_pk_fma_f32 v[42:43], v[42:43], v[208:209], v[208:209] op_sel_hi:[1,0,0]
    v_pk_fma_f32 v[44:45], v[44:45], v[208:209], v[208:209] op_sel_hi:[1,0,0]
    v_pk_fma_f32 v[46:47], v[46:47], v[208:209], v[208:209] op_sel_hi:[1,0,0]
    v_rcp_f32 v40, v40
    v_rcp_f32 v41, v41
    v_rcp_f32 v42, v42
    v_rcp_f32 v43, v43
    v_rcp_f32 v44, v44
    v_rcp_f32 v45, v45
    v_rcp_f32 v46, v46
    v_rcp_f32 v47, v47
    v_pk_mul_f32 v[40:41], v[40:41], v[96:97]
    v_pk_mul_f32 v[42:43], v[42:43], v[98:99]
    v_pk_mul_f32 v[44:45], v[44:45], v[112:113]
    v_pk_mul_f32 v[46:47], v[46:47], v[114:115]
    v_cvt_pk_bf16_f32 v56, v40, v41
    v_cvt_pk_bf16_f32 v57, v42, v43
    v_cvt_pk_bf16_f32 v58, v44, v45
    v_cvt_pk_bf16_f32 v59, v46, v47
    buffer_store_dwordx4 v[56:59], v251, s[16:19], s47 offen offset:0 sc1
    v_pk_mul_f32 v[48:49], v[100:101], v[100:101]
    v_pk_mul_f32 v[50:51], v[102:103], v[102:103]
    v_pk_mul_f32 v[52:53], v[116:117], v[116:117]
    v_pk_mul_f32 v[54:55], v[118:119], v[118:119]
    v_pk_fma_f32 v[48:49], v[48:49], v[218:219], v[66:67] op_sel_hi:[1,0,0]
    v_pk_fma_f32 v[50:51], v[50:51], v[218:219], v[66:67] op_sel_hi:[1,0,0]
    v_pk_fma_f32 v[52:53], v[52:53], v[218:219], v[66:67] op_sel_hi:[1,0,0]
    v_pk_fma_f32 v[54:55], v[54:55], v[218:219], v[66:67] op_sel_hi:[1,0,0]
    v_pk_mul_f32 v[48:49], v[48:49], v[100:101]
    v_pk_mul_f32 v[50:51], v[50:51], v[102:103]
    v_pk_mul_f32 v[52:53], v[52:53], v[116:117]
    v_pk_mul_f32 v[54:55], v[54:55], v[118:119]
    v_exp_f32_e64 v48, v48
    v_mfma_f32_16x16x32_bf16 v[132:135], v[24:27], v[196:199], v[132:135]
    v_exp_f32 v49, v49
    v_exp_f32 v50, v50
    v_mfma_f32_16x16x32_bf16 v[148:151], v[28:31], v[196:199], v[148:151]
    v_exp_f32 v51, v51
    v_exp_f32 v52, v52
    v_exp_f32 v53, v53
    v_exp_f32 v54, v54
    v_exp_f32_e64 v55, v55
    v_pk_fma_f32 v[48:49], v[48:49], v[210:211], v[210:211] op_sel_hi:[1,0,0]
    v_pk_fma_f32 v[50:51], v[50:51], v[210:211], v[210:211] op_sel_hi:[1,0,0]
    v_pk_fma_f32 v[52:53], v[52:53], v[210:211], v[210:211] op_sel_hi:[1,0,0]
    v_pk_fma_f32 v[54:55], v[54:55], v[210:211], v[210:211] op_sel_hi:[1,0,0]
    v_rcp_f32 v48, v48
    v_rcp_f32 v49, v49
    v_rcp_f32 v50, v50
    v_rcp_f32 v51, v51
    v_rcp_f32 v52, v52
    v_rcp_f32 v53, v53
    v_rcp_f32 v54, v54
    v_rcp_f32 v55, v55
    v_pk_mul_f32 v[48:49], v[48:49], v[100:101]
    v_pk_mul_f32 v[50:51], v[50:51], v[102:103]
    v_pk_mul_f32 v[52:53], v[52:53], v[116:117]
    v_pk_mul_f32 v[54:55], v[54:55], v[118:119]
    v_cvt_pk_bf16_f32 v60, v48, v49
    v_cvt_pk_bf16_f32 v61, v50, v51
    v_cvt_pk_bf16_f32 v62, v52, v53
    v_cvt_pk_bf16_f32 v63, v54, v55
    buffer_store_dwordx4 v[60:63], v251, s[16:19], s47 offen offset:1024 sc1
    v_pk_mul_f32 v[40:41], v[104:105], v[104:105]
    v_pk_mul_f32 v[42:43], v[106:107], v[106:107]
    v_pk_mul_f32 v[44:45], v[120:121], v[120:121]
    v_pk_mul_f32 v[46:47], v[122:123], v[122:123]
    v_pk_fma_f32 v[40:41], v[40:41], v[220:221], v[68:69] op_sel_hi:[1,0,0]
    v_pk_fma_f32 v[42:43], v[42:43], v[220:221], v[68:69] op_sel_hi:[1,0,0]
    v_pk_fma_f32 v[44:45], v[44:45], v[220:221], v[68:69] op_sel_hi:[1,0,0]
    v_pk_fma_f32 v[46:47], v[46:47], v[220:221], v[68:69] op_sel_hi:[1,0,0]
    v_pk_mul_f32 v[40:41], v[40:41], v[104:105]
    v_pk_mul_f32 v[42:43], v[42:43], v[106:107]
    v_pk_mul_f32 v[44:45], v[44:45], v[120:121]
    v_pk_mul_f32 v[46:47], v[46:47], v[122:123]
    v_exp_f32_e64 v40, v40
    v_mfma_f32_16x16x32_bf16 v[136:139], v[24:27], v[200:203], v[136:139]
    v_exp_f32 v41, v41
    v_exp_f32 v42, v42
    v_mfma_f32_16x16x32_bf16 v[152:155], v[28:31], v[200:203], v[152:155]
    v_exp_f32 v43, v43
    v_exp_f32 v44, v44
    v_exp_f32 v45, v45
    v_exp_f32 v46, v46
    v_exp_f32_e64 v47, v47
    v_pk_fma_f32 v[40:41], v[40:41], v[212:213], v[212:213] op_sel_hi:[1,0,0]
    v_pk_fma_f32 v[42:43], v[42:43], v[212:213], v[212:213] op_sel_hi:[1,0,0]
    v_pk_fma_f32 v[44:45], v[44:45], v[212:213], v[212:213] op_sel_hi:[1,0,0]
    v_pk_fma_f32 v[46:47], v[46:47], v[212:213], v[212:213] op_sel_hi:[1,0,0]
    v_rcp_f32 v40, v40
    v_rcp_f32 v41, v41
    v_rcp_f32 v42, v42
    v_rcp_f32 v43, v43
    v_rcp_f32 v44, v44
    v_rcp_f32 v45, v45
    v_rcp_f32 v46, v46
    v_rcp_f32 v47, v47
    v_pk_mul_f32 v[40:41], v[40:41], v[104:105]
    v_pk_mul_f32 v[42:43], v[42:43], v[106:107]
    v_pk_mul_f32 v[44:45], v[44:45], v[120:121]
    v_pk_mul_f32 v[46:47], v[46:47], v[122:123]
    v_cvt_pk_bf16_f32 v56, v40, v41
    v_cvt_pk_bf16_f32 v57, v42, v43
    v_cvt_pk_bf16_f32 v58, v44, v45
    v_cvt_pk_bf16_f32 v59, v46, v47
    buffer_store_dwordx4 v[56:59], v251, s[16:19], s47 offen offset:2048 sc1
    v_pk_mul_f32 v[48:49], v[108:109], v[108:109]
    v_pk_mul_f32 v[50:51], v[110:111], v[110:111]
    v_pk_mul_f32 v[52:53], v[124:125], v[124:125]
    v_pk_mul_f32 v[54:55], v[126:127], v[126:127]
    v_pk_fma_f32 v[48:49], v[48:49], v[222:223], v[70:71] op_sel_hi:[1,0,0]
    v_pk_fma_f32 v[50:51], v[50:51], v[222:223], v[70:71] op_sel_hi:[1,0,0]
    v_pk_fma_f32 v[52:53], v[52:53], v[222:223], v[70:71] op_sel_hi:[1,0,0]
    v_pk_fma_f32 v[54:55], v[54:55], v[222:223], v[70:71] op_sel_hi:[1,0,0]
    v_pk_mul_f32 v[48:49], v[48:49], v[108:109]
    v_pk_mul_f32 v[50:51], v[50:51], v[110:111]
    v_pk_mul_f32 v[52:53], v[52:53], v[124:125]
    v_pk_mul_f32 v[54:55], v[54:55], v[126:127]
    v_exp_f32_e64 v48, v48
    v_mfma_f32_16x16x32_bf16 v[140:143], v[24:27], v[204:207], v[140:143]
    v_exp_f32 v49, v49
    v_exp_f32 v50, v50
    v_mfma_f32_16x16x32_bf16 v[156:159], v[28:31], v[204:207], v[156:159]
    v_exp_f32 v51, v51
    v_exp_f32 v52, v52
    v_exp_f32 v53, v53
    v_exp_f32 v54, v54
    v_exp_f32_e64 v55, v55
    v_pk_fma_f32 v[48:49], v[48:49], v[214:215], v[214:215] op_sel_hi:[1,0,0]
    v_pk_fma_f32 v[50:51], v[50:51], v[214:215], v[214:215] op_sel_hi:[1,0,0]
    v_pk_fma_f32 v[52:53], v[52:53], v[214:215], v[214:215] op_sel_hi:[1,0,0]
    v_pk_fma_f32 v[54:55], v[54:55], v[214:215], v[214:215] op_sel_hi:[1,0,0]
    v_rcp_f32 v48, v48
    v_rcp_f32 v49, v49
    v_rcp_f32 v50, v50
    v_rcp_f32 v51, v51
    v_rcp_f32 v52, v52
    v_rcp_f32 v53, v53
    v_rcp_f32 v54, v54
    v_rcp_f32 v55, v55
    v_pk_mul_f32 v[48:49], v[48:49], v[108:109]
    v_pk_mul_f32 v[50:51], v[50:51], v[110:111]
    v_pk_mul_f32 v[52:53], v[52:53], v[124:125]
    v_pk_mul_f32 v[54:55], v[54:55], v[126:127]
    v_cvt_pk_bf16_f32 v60, v48, v49
    v_cvt_pk_bf16_f32 v61, v50, v51
    v_cvt_pk_bf16_f32 v62, v52, v53
    v_cvt_pk_bf16_f32 v63, v54, v55
    buffer_store_dwordx4 v[60:63], v251, s[16:19], s47 offen offset:3072 sc1
    s_add_u32 s47, s47, 8192
    v_pk_mul_f32 v[40:41], v[128:129], v[128:129]
    v_pk_mul_f32 v[42:43], v[130:131], v[130:131]
    v_pk_mul_f32 v[44:45], v[144:145], v[144:145]
    v_pk_mul_f32 v[46:47], v[146:147], v[146:147]
    v_pk_fma_f32 v[40:41], v[40:41], v[216:217], v[64:65] op_sel_hi:[1,0,0]
    v_pk_fma_f32 v[42:43], v[42:43], v[216:217], v[64:65] op_sel_hi:[1,0,0]
    v_pk_fma_f32 v[44:45], v[44:45], v[216:217], v[64:65] op_sel_hi:[1,0,0]
    v_pk_fma_f32 v[46:47], v[46:47], v[216:217], v[64:65] op_sel_hi:[1,0,0]
    v_pk_mul_f32 v[40:41], v[40:41], v[128:129]
    v_pk_mul_f32 v[42:43], v[42:43], v[130:131]
    v_pk_mul_f32 v[44:45], v[44:45], v[144:145]
    v_pk_mul_f32 v[46:47], v[46:47], v[146:147]
    v_exp_f32_e64 v40, v40
    v_mfma_f32_16x16x32_bf16 v[160:163], v[32:35], v[192:195], v[160:163]
    v_exp_f32 v41, v41
    v_exp_f32 v42, v42
    v_mfma_f32_16x16x32_bf16 v[176:179], v[36:39], v[192:195], v[176:179]
    v_exp_f32 v43, v43
    v_exp_f32 v44, v44
    v_exp_f32 v45, v45
    v_exp_f32 v46, v46
    v_exp_f32_e64 v47, v47
    v_pk_fma_f32 v[40:41], v[40:41], v[208:209], v[208:209] op_sel_hi:[1,0,0]
    v_pk_fma_f32 v[42:43], v[42:43], v[208:209], v[208:209] op_sel_hi:[1,0,0]
    v_pk_fma_f32 v[44:45], v[44:45], v[208:209], v[208:209] op_sel_hi:[1,0,0]
    v_pk_fma_f32 v[46:47], v[46:47], v[208:209], v[208:209] op_sel_hi:[1,0,0]
    v_rcp_f32 v40, v40
    v_rcp_f32 v41, v41
    v_rcp_f32 v42, v42
    v_rcp_f32 v43, v43
    v_rcp_f32 v44, v44
    v_rcp_f32 v45, v45
    v_rcp_f32 v46, v46
    v_rcp_f32 v47, v47
    v_pk_mul_f32 v[40:41], v[40:41], v[128:129]
    v_pk_mul_f32 v[42:43], v[42:43], v[130:131]
    v_pk_mul_f32 v[44:45], v[44:45], v[144:145]
    v_pk_mul_f32 v[46:47], v[46:47], v[146:147]
    v_cvt_pk_bf16_f32 v56, v40, v41
    v_cvt_pk_bf16_f32 v57, v42, v43
    v_cvt_pk_bf16_f32 v58, v44, v45
    v_cvt_pk_bf16_f32 v59, v46, v47
    buffer_store_dwordx4 v[56:59], v251, s[16:19], s47 offen offset:0 sc1
    v_pk_mul_f32 v[48:49], v[132:133], v[132:133]
    v_pk_mul_f32 v[50:51], v[134:135], v[134:135]
    v_pk_mul_f32 v[52:53], v[148:149], v[148:149]
    v_pk_mul_f32 v[54:55], v[150:151], v[150:151]
    v_pk_fma_f32 v[48:49], v[48:49], v[218:219], v[66:67] op_sel_hi:[1,0,0]
    v_pk_fma_f32 v[50:51], v[50:51], v[218:219], v[66:67] op_sel_hi:[1,0,0]
    v_pk_fma_f32 v[52:53], v[52:53], v[218:219], v[66:67] op_sel_hi:[1,0,0]
    v_pk_fma_f32 v[54:55], v[54:55], v[218:219], v[66:67] op_sel_hi:[1,0,0]
    v_pk_mul_f32 v[48:49], v[48:49], v[132:133]
    v_pk_mul_f32 v[50:51], v[50:51], v[134:135]
    v_pk_mul_f32 v[52:53], v[52:53], v[148:149]
    v_pk_mul_f32 v[54:55], v[54:55], v[150:151]
    v_exp_f32_e64 v48, v48
    v_mfma_f32_16x16x32_bf16 v[164:167], v[32:35], v[196:199], v[164:167]
    v_exp_f32 v49, v49
    v_exp_f32 v50, v50
    v_mfma_f32_16x16x32_bf16 v[180:183], v[36:39], v[196:199], v[180:183]
    v_exp_f32 v51, v51
    v_exp_f32 v52, v52
    v_exp_f32 v53, v53
    v_exp_f32 v54, v54
    v_exp_f32_e64 v55, v55
    v_pk_fma_f32 v[48:49], v[48:49], v[210:211], v[210:211] op_sel_hi:[1,0,0]
    v_pk_fma_f32 v[50:51], v[50:51], v[210:211], v[210:211] op_sel_hi:[1,0,0]
    v_pk_fma_f32 v[52:53], v[52:53], v[210:211], v[210:211] op_sel_hi:[1,0,0]
    v_pk_fma_f32 v[54:55], v[54:55], v[210:211], v[210:211] op_sel_hi:[1,0,0]
    v_rcp_f32 v48, v48
    v_rcp_f32 v49, v49
    v_rcp_f32 v50, v50
    v_rcp_f32 v51, v51
    v_rcp_f32 v52, v52
    v_rcp_f32 v53, v53
    v_rcp_f32 v54, v54
    v_rcp_f32 v55, v55
    v_pk_mul_f32 v[48:49], v[48:49], v[132:133]
    v_pk_mul_f32 v[50:51], v[50:51], v[134:135]
    v_pk_mul_f32 v[52:53], v[52:53], v[148:149]
    v_pk_mul_f32 v[54:55], v[54:55], v[150:151]
    v_cvt_pk_bf16_f32 v60, v48, v49
    v_cvt_pk_bf16_f32 v61, v50, v51
    v_cvt_pk_bf16_f32 v62, v52, v53
    v_cvt_pk_bf16_f32 v63, v54, v55
    buffer_store_dwordx4 v[60:63], v251, s[16:19], s47 offen offset:1024 sc1
    s_waitcnt vmcnt(2)
    s_mov_b32 exec_hi, 0
    buffer_store_dword v1, v14, s[16:19], s50 offen offset:0 sc1
    s_mov_b32 exec_hi, -1
    v_pk_mul_f32 v[40:41], v[136:137], v[136:137]
    v_pk_mul_f32 v[42:43], v[138:139], v[138:139]
    v_pk_mul_f32 v[44:45], v[152:153], v[152:153]
    v_pk_mul_f32 v[46:47], v[154:155], v[154:155]
    v_pk_fma_f32 v[40:41], v[40:41], v[220:221], v[68:69] op_sel_hi:[1,0,0]
    v_pk_fma_f32 v[42:43], v[42:43], v[220:221], v[68:69] op_sel_hi:[1,0,0]
    v_pk_fma_f32 v[44:45], v[44:45], v[220:221], v[68:69] op_sel_hi:[1,0,0]
    v_pk_fma_f32 v[46:47], v[46:47], v[220:221], v[68:69] op_sel_hi:[1,0,0]
    v_pk_mul_f32 v[40:41], v[40:41], v[136:137]
    v_pk_mul_f32 v[42:43], v[42:43], v[138:139]
    v_pk_mul_f32 v[44:45], v[44:45], v[152:153]
    v_pk_mul_f32 v[46:47], v[46:47], v[154:155]
    v_exp_f32 v40, v40
    v_mfma_f32_16x16x32_bf16 v[168:171], v[32:35], v[200:203], v[168:171]
    v_exp_f32 v41, v41
    v_exp_f32 v42, v42
    v_mfma_f32_16x16x32_bf16 v[184:187], v[36:39], v[200:203], v[184:187]
    v_exp_f32 v43, v43
    v_exp_f32 v44, v44
    v_exp_f32 v45, v45
    v_exp_f32 v46, v46
    v_exp_f32_e64 v47, v47
    v_pk_fma_f32 v[40:41], v[40:41], v[212:213], v[212:213] op_sel_hi:[1,0,0]
    v_pk_fma_f32 v[42:43], v[42:43], v[212:213], v[212:213] op_sel_hi:[1,0,0]
    v_pk_fma_f32 v[44:45], v[44:45], v[212:213], v[212:213] op_sel_hi:[1,0,0]
    v_pk_fma_f32 v[46:47], v[46:47], v[212:213], v[212:213] op_sel_hi:[1,0,0]
    v_rcp_f32 v40, v40
    v_rcp_f32 v41, v41
    v_rcp_f32 v42, v42
    v_rcp_f32 v43, v43
    v_rcp_f32 v44, v44
    v_rcp_f32 v45, v45
    v_rcp_f32 v46, v46
    v_rcp_f32 v47, v47
    v_pk_mul_f32 v[40:41], v[40:41], v[136:137]
    v_pk_mul_f32 v[42:43], v[42:43], v[138:139]
    v_pk_mul_f32 v[44:45], v[44:45], v[152:153]
    v_pk_mul_f32 v[46:47], v[46:47], v[154:155]
    v_cvt_pk_bf16_f32 v56, v40, v41
    v_cvt_pk_bf16_f32 v57, v42, v43
    v_cvt_pk_bf16_f32 v58, v44, v45
    v_cvt_pk_bf16_f32 v59, v46, v47
    buffer_store_dwordx4 v[56:59], v251, s[16:19], s47 offen offset:2048 sc1
    v_pk_mul_f32 v[48:49], v[140:141], v[140:141]
    v_pk_mul_f32 v[50:51], v[142:143], v[142:143]
    v_pk_mul_f32 v[52:53], v[156:157], v[156:157]
    v_pk_mul_f32 v[54:55], v[158:159], v[158:159]
    v_pk_fma_f32 v[48:49], v[48:49], v[222:223], v[70:71] op_sel_hi:[1,0,0]
    v_pk_fma_f32 v[50:51], v[50:51], v[222:223], v[70:71] op_sel_hi:[1,0,0]
    v_pk_fma_f32 v[52:53], v[52:53], v[222:223], v[70:71] op_sel_hi:[1,0,0]
    v_pk_fma_f32 v[54:55], v[54:55], v[222:223], v[70:71] op_sel_hi:[1,0,0]
    v_pk_mul_f32 v[48:49], v[48:49], v[140:141]
    v_pk_mul_f32 v[50:51], v[50:51], v[142:143]
    v_pk_mul_f32 v[52:53], v[52:53], v[156:157]
    v_pk_mul_f32 v[54:55], v[54:55], v[158:159]
    v_exp_f32_e64 v48, v48
    v_mfma_f32_16x16x32_bf16 v[172:175], v[32:35], v[204:207], v[172:175]
    v_exp_f32 v49, v49
    v_exp_f32 v50, v50
    v_mfma_f32_16x16x32_bf16 v[188:191], v[36:39], v[204:207], v[188:191]
    v_exp_f32 v51, v51
    v_exp_f32 v52, v52
    v_exp_f32 v53, v53
    v_exp_f32 v54, v54
    v_exp_f32_e64 v55, v55
    v_pk_fma_f32 v[48:49], v[48:49], v[214:215], v[214:215] op_sel_hi:[1,0,0]
    v_pk_fma_f32 v[50:51], v[50:51], v[214:215], v[214:215] op_sel_hi:[1,0,0]
    v_pk_fma_f32 v[52:53], v[52:53], v[214:215], v[214:215] op_sel_hi:[1,0,0]
    v_pk_fma_f32 v[54:55], v[54:55], v[214:215], v[214:215] op_sel_hi:[1,0,0]
    v_rcp_f32 v48, v48
    v_rcp_f32 v49, v49
    v_rcp_f32 v50, v50
    v_rcp_f32 v51, v51
    v_rcp_f32 v52, v52
    v_rcp_f32 v53, v53
    v_rcp_f32 v54, v54
    v_rcp_f32 v55, v55
    v_pk_mul_f32 v[48:49], v[48:49], v[140:141]
    v_pk_mul_f32 v[50:51], v[50:51], v[142:143]
    v_pk_mul_f32 v[52:53], v[52:53], v[156:157]
    v_pk_mul_f32 v[54:55], v[54:55], v[158:159]
    v_cvt_pk_bf16_f32 v60, v48, v49
    v_cvt_pk_bf16_f32 v61, v50, v51
    v_cvt_pk_bf16_f32 v62, v52, v53
    v_cvt_pk_bf16_f32 v63, v54, v55
    buffer_store_dwordx4 v[60:63], v251, s[16:19], s47 offen offset:3072 sc1
    s_add_u32 s47, s47, 8192
    s_sub_u32 s5, 1, s41
    s_or_b32 s5, s5, s78
    s_cmp_eq_u32 s5, 0
    s_cbranch_scc1 L_gelu_skip
    v_pk_mul_f32 v[40:41], v[160:161], v[160:161]
    v_pk_mul_f32 v[42:43], v[162:163], v[162:163]
    v_pk_mul_f32 v[44:45], v[176:177], v[176:177]
    v_pk_mul_f32 v[46:47], v[178:179], v[178:179]
    v_pk_fma_f32 v[40:41], v[40:41], v[216:217], v[64:65] op_sel_hi:[1,0,0]
    v_pk_fma_f32 v[42:43], v[42:43], v[216:217], v[64:65] op_sel_hi:[1,0,0]
    v_pk_fma_f32 v[44:45], v[44:45], v[216:217], v[64:65] op_sel_hi:[1,0,0]
    v_pk_fma_f32 v[46:47], v[46:47], v[216:217], v[64:65] op_sel_hi:[1,0,0]
    v_pk_mul_f32 v[40:41], v[40:41], v[160:161]
    v_pk_mul_f32 v[42:43], v[42:43], v[162:163]
    v_pk_mul_f32 v[44:45], v[44:45], v[176:177]
    v_pk_mul_f32 v[46:47], v[46:47], v[178:179]
    v_exp_f32 v40, v40
    v_exp_f32 v41, v41
    v_exp_f32 v42, v42
    v_exp_f32 v43, v43
    v_exp_f32 v44, v44
    v_exp_f32 v45, v45
    v_exp_f32 v46, v46
    v_exp_f32 v47, v47
    v_pk_fma_f32 v[40:41], v[40:41], v[208:209], v[208:209] op_sel_hi:[1,0,0]
    v_pk_fma_f32 v[42:43], v[42:43], v[208:209], v[208:209] op_sel_hi:[1,0,0]
    v_pk_fma_f32 v[44:45], v[44:45], v[208:209], v[208:209] op_sel_hi:[1,0,0]
    v_pk_fma_f32 v[46:47], v[46:47], v[208:209], v[208:209] op_sel_hi:[1,0,0]
    v_rcp_f32 v40, v40
    v_rcp_f32 v41, v41
    v_rcp_f32 v42, v42
    v_rcp_f32 v43, v43
    v_rcp_f32 v44, v44
    v_rcp_f32 v45, v45
    v_rcp_f32 v46, v46
    v_rcp_f32 v47, v47
    v_pk_mul_f32 v[40:41], v[40:41], v[160:161]
    v_pk_mul_f32 v[42:43], v[42:43], v[162:163]
    v_pk_mul_f32 v[44:45], v[44:45], v[176:177]
    v_pk_mul_f32 v[46:47], v[46:47], v[178:179]
    v_cvt_pk_bf16_f32 v56, v40, v41
    v_cvt_pk_bf16_f32 v57, v42, v43
    v_cvt_pk_bf16_f32 v58, v44, v45
    v_cvt_pk_bf16_f32 v59, v46, v47
    buffer_store_dwordx4 v[56:59], v251, s[16:19], s47 offen offset:0 sc1
    v_pk_mul_f32 v[48:49], v[164:165], v[164:165]
    v_pk_mul_f32 v[50:51], v[166:167], v[166:167]
    v_pk_mul_f32 v[52:53], v[180:181], v[180:181]
    v_pk_mul_f32 v[54:55], v[182:183], v[182:183]
    v_pk_fma_f32 v[48:49], v[48:49], v[218:219], v[66:67] op_sel_hi:[1,0,0]
    v_pk_fma_f32 v[50:51], v[50:51], v[218:219], v[66:67] op_sel_hi:[1,0,0]
    v_pk_fma_f32 v[52:53], v[52:53], v[218:219], v[66:67] op_sel_hi:[1,0,0]
    v_pk_fma_f32 v[54:55], v[54:55], v[218:219], v[66:67] op_sel_hi:[1,0,0]
    v_pk_mul_f32 v[48:49], v[48:49], v[164:165]
    v_pk_mul_f32 v[50:51], v[50:51], v[166:167]
    v_pk_mul_f32 v[52:53], v[52:53], v[180:181]
    v_pk_mul_f32 v[54:55], v[54:55], v[182:183]
    v_exp_f32 v48, v48
    v_exp_f32 v49, v49
    v_exp_f32 v50, v50
    v_exp_f32 v51, v51
    v_exp_f32 v52, v52
    v_exp_f32 v53, v53
    v_exp_f32 v54, v54
    v_exp_f32 v55, v55
    v_pk_fma_f32 v[48:49], v[48:49], v[210:211], v[210:211] op_sel_hi:[1,0,0]
    v_pk_fma_f32 v[50:51], v[50:51], v[210:211], v[210:211] op_sel_hi:[1,0,0]
    v_pk_fma_f32 v[52:53], v[52:53], v[210:211], v[210:211] op_sel_hi:[1,0,0]
    v_pk_fma_f32 v[54:55], v[54:55], v[210:211], v[210:211] op_sel_hi:[1,0,0]
    v_rcp_f32 v48, v48
    v_rcp_f32 v49, v49
    v_rcp_f32 v50, v50
    v_rcp_f32 v51, v51
    v_rcp_f32 v52, v52
    v_rcp_f32 v53, v53
    v_rcp_f32 v54, v54
    v_rcp_f32 v55, v55
    v_pk_mul_f32 v[48:49], v[48:49], v[164:165]
    v_pk_mul_f32 v[50:51], v[50:51], v[166:167]
    v_pk_mul_f32 v[52:53], v[52:53], v[180:181]
    v_pk_mul_f32 v[54:55], v[54:55], v[182:183]
    v_cvt_pk_bf16_f32 v60, v48, v49
    v_cvt_pk_bf16_f32 v61, v50, v51
    v_cvt_pk_bf16_f32 v62, v52, v53
    v_cvt_pk_bf16_f32 v63, v54, v55
    buffer_store_dwordx4 v[60:63], v251, s[16:19], s47 offen offset:1024 sc1
    s_waitcnt vmcnt(2)
    s_mov_b32 exec_hi, 0
    buffer_store_dword v1, v14, s[16:19], s50 offen offset:2048 sc1
    s_mov_b32 exec_hi, -1
    v_pk_mul_f32 v[40:41], v[168:169], v[168:169]
    v_pk_mul_f32 v[42:43], v[170:171], v[170:171]
    v_pk_mul_f32 v[44:45], v[184:185], v[184:185]
    v_pk_mul_f32 v[46:47], v[186:187], v[186:187]
    v_pk_fma_f32 v[40:41], v[40:41], v[220:221], v[68:69] op_sel_hi:[1,0,0]
    v_pk_fma_f32 v[42:43], v[42:43], v[220:221], v[68:69] op_sel_hi:[1,0,0]
    v_pk_fma_f32 v[44:45], v[44:45], v[220:221], v[68:69] op_sel_hi:[1,0,0]
    v_pk_fma_f32 v[46:47], v[46:47], v[220:221], v[68:69] op_sel_hi:[1,0,0]
    v_pk_mul_f32 v[40:41], v[40:41], v[168:169]
    v_pk_mul_f32 v[42:43], v[42:43], v[170:171]
    v_pk_mul_f32 v[44:45], v[44:45], v[184:185]
    v_pk_mul_f32 v[46:47], v[46:47], v[186:187]
    v_exp_f32 v40, v40
    v_exp_f32 v41, v41
    v_exp_f32 v42, v42
    v_exp_f32 v43, v43
    v_exp_f32 v44, v44
    v_exp_f32 v45, v45
    v_exp_f32 v46, v46
    v_exp_f32_e64 v47, v47
    v_pk_fma_f32 v[40:41], v[40:41], v[212:213], v[212:213] op_sel_hi:[1,0,0]
    v_pk_fma_f32 v[42:43], v[42:43], v[212:213], v[212:213] op_sel_hi:[1,0,0]
    v_pk_fma_f32 v[44:45], v[44:45], v[212:213], v[212:213] op_sel_hi:[1,0,0]
    v_pk_fma_f32 v[46:47], v[46:47], v[212:213], v[212:213] op_sel_hi:[1,0,0]
    v_rcp_f32 v40, v40
    v_rcp_f32 v41, v41
    v_rcp_f32 v42, v42
    v_rcp_f32 v43, v43
    v_rcp_f32 v44, v44
    v_rcp_f32 v45, v45
    v_rcp_f32 v46, v46
    v_rcp_f32 v47, v47
    v_pk_mul_f32 v[40:41], v[40:41], v[168:169]
    v_pk_mul_f32 v[42:43], v[42:43], v[170:171]
    v_pk_mul_f32 v[44:45], v[44:45], v[184:185]
    v_pk_mul_f32 v[46:47], v[46:47], v[186:187]
    v_cvt_pk_bf16_f32 v56, v40, v41
    v_cvt_pk_bf16_f32 v57, v42, v43
    v_cvt_pk_bf16_f32 v58, v44, v45
    v_cvt_pk_bf16_f32 v59, v46, v47
    buffer_store_dwordx4 v[56:59], v251, s[16:19], s47 offen offset:2048 sc1
    v_pk_mul_f32 v[48:49], v[172:173], v[172:173]
    v_pk_mul_f32 v[50:51], v[174:175], v[174:175]
    v_pk_mul_f32 v[52:53], v[188:189], v[188:189]
    v_pk_mul_f32 v[54:55], v[190:191], v[190:191]
    v_pk_fma_f32 v[48:49], v[48:49], v[222:223], v[70:71] op_sel_hi:[1,0,0]
    v_pk_fma_f32 v[50:51], v[50:51], v[222:223], v[70:71] op_sel_hi:[1,0,0]
    v_pk_fma_f32 v[52:53], v[52:53], v[222:223], v[70:71] op_sel_hi:[1,0,0]
    v_pk_fma_f32 v[54:55], v[54:55], v[222:223], v[70:71] op_sel_hi:[1,0,0]
    v_pk_mul_f32 v[48:49], v[48:49], v[172:173]
    v_pk_mul_f32 v[50:51], v[50:51], v[174:175]
    v_pk_mul_f32 v[52:53], v[52:53], v[188:189]
    v_pk_mul_f32 v[54:55], v[54:55], v[190:191]
    v_exp_f32 v48, v48
    v_exp_f32 v49, v49
    v_exp_f32 v50, v50
    v_exp_f32 v51, v51
    v_exp_f32 v52, v52
    v_exp_f32 v53, v53
    v_exp_f32 v54, v54
    v_exp_f32 v55, v55
    v_pk_fma_f32 v[48:49], v[48:49], v[214:215], v[214:215] op_sel_hi:[1,0,0]
    v_pk_fma_f32 v[50:51], v[50:51], v[214:215], v[214:215] op_sel_hi:[1,0,0]
    v_pk_fma_f32 v[52:53], v[52:53], v[214:215], v[214:215] op_sel_hi:[1,0,0]
    v_pk_fma_f32 v[54:55], v[54:55], v[214:215], v[214:215] op_sel_hi:[1,0,0]
    v_rcp_f32 v48, v48
    v_rcp_f32 v49, v49
    v_rcp_f32 v50, v50
    v_rcp_f32 v51, v51
    v_rcp_f32 v52, v52
    v_rcp_f32 v53, v53
    v_rcp_f32 v54, v54
    v_rcp_f32 v55, v55
    v_pk_mul_f32 v[48:49], v[48:49], v[172:173]
    v_pk_mul_f32 v[50:51], v[50:51], v[174:175]
    v_pk_mul_f32 v[52:53], v[52:53], v[188:189]
    v_pk_mul_f32 v[54:55], v[54:55], v[190:191]
    v_cvt_pk_bf16_f32 v60, v48, v49
    v_cvt_pk_bf16_f32 v61, v50, v51
    v_cvt_pk_bf16_f32 v62, v52, v53
    v_cvt_pk_bf16_f32 v63, v54, v55
    buffer_store_dwordx4 v[60:63], v251, s[16:19], s47 offen offset:3072 sc1
    s_barrier
    s_branch L_gelu_e
L_gelu_skip:
    s_waitcnt vmcnt(0)
    s_mov_b32 exec_hi, 0
    buffer_store_dword v1, v14, s[16:19], s50 offen offset:2048 sc1
    s_mov_b32 exec_hi, -1
    s_barrier
L_gelu_e:
    s_add_u32 s50, s50, 4096
    s_add_u32 m0, s42, 65536
    s_add_u32 s6, s44, 4
    s_lshl_b32 s6, s6, 15
    s_add_u32 s6, s6, s51
    buffer_load_dwordx4 v224, s[20:23], s6 offen offset:0 lds
    buffer_load_dwordx4 v225, s[20:23], s6 offen offset:1024 lds
    buffer_load_dwordx4 v226, s[20:23], s6 offen offset:2048 lds
    buffer_load_dwordx4 v227, s[20:23], s6 offen offset:3072 lds
    s_waitcnt vmcnt(4)
    s_mov_b32 exec_hi, 0
    buffer_store_dword v1, v14, s[16:19], s50 offen offset:0 sc1
    s_mov_b32 exec_hi, -1
    s_setprio 0
    s_barrier
    s_add_u32 m0, s42, 147456
    s_add_u32 s6, s45, 4
    s_lshl_b32 s6, s6, 15
    s_add_u32 s6, s6, s51
    buffer_load_dwordx4 v224, s[20:23], s6 offen offset:0 lds
    buffer_load_dwordx4 v225, s[20:23], s6 offen offset:1024 lds
    buffer_load_dwordx4 v226, s[20:23], s6 offen offset:2048 lds
    buffer_load_dwordx4 v227, s[20:23], s6 offen offset:3072 lds
    s_branch L_ph2
L_Catt:
    ds_read_b64_tr_b16 v[68:69], v250
    ds_read_b64_tr_b16 v[70:71], v250 offset:128
    ds_read_b32 v216, v13
    ds_read_b32 v218, v13 offset:256
    v_mfma_f32_16x16x32_bf16 v[128:131], v[24:27], v[192:195], v[128:131]
    v_mfma_f32_16x16x32_bf16 v[144:147], v[28:31], v[192:195], v[144:147]
    v_mfma_f32_16x16x32_bf16 v[132:135], v[24:27], v[196:199], v[132:135]
    v_mfma_f32_16x16x32_bf16 v[148:151], v[28:31], v[196:199], v[148:151]
    v_mfma_f32_16x16x32_bf16 v[136:139], v[24:27], v[200:203], v[136:139]
    v_mfma_f32_16x16x32_bf16 v[152:155], v[28:31], v[200:203], v[152:155]
    v_mfma_f32_16x16x32_bf16 v[140:143], v[24:27], v[204:207], v[140:143]
    v_mfma_f32_16x16x32_bf16 v[156:159], v[28:31], v[204:207], v[156:159]
    v_and_b32 v2, 4, v0
    v_cmp_eq_u32 vcc, 0, v2
    s_waitcnt lgkmcnt(0)
    s_nop 0
    v_cndmask_b32 v64, 0, v68, vcc
    v_cndmask_b32 v65, 0, v69, vcc
    v_cndmask_b32 v66, 0, v70, vcc
    v_cndmask_b32 v67, 0, v71, vcc
    v_cndmask_b32 v68, v68, 0, vcc
    v_cndmask_b32 v69, v69, 0, vcc
    v_cndmask_b32 v70, v70, 0, vcc
    v_cndmask_b32 v71, v71, 0, vcc
    v_mfma_f32_16x16x32_bf16 v[160:163], v[32:35], v[192:195], v[160:163]
    v_cvt_pk_bf16_f32 v72, v128, v129
    v_cvt_pk_bf16_f32 v73, v130, v131
    v_mfma_f32_16x16x32_bf16 v[176:179], v[36:39], v[192:195], v[176:179]
    v_cvt_pk_bf16_f32 v74, v132, v133
    v_cvt_pk_bf16_f32 v75, v134, v135
    v_mfma_f32_16x16x32_bf16 v[164:167], v[32:35], v[196:199], v[164:167]
    v_cvt_pk_bf16_f32 v76, v144, v145
    v_cvt_pk_bf16_f32 v77, v146, v147
    v_mfma_f32_16x16x32_bf16 v[180:183], v[36:39], v[196:199], v[180:183]
    v_cvt_pk_bf16_f32 v78, v148, v149
    v_cvt_pk_bf16_f32 v79, v150, v151
    v_mfma_f32_16x16x32_bf16 v[168:171], v[32:35], v[200:203], v[168:171]
    v_cvt_pk_bf16_f32 v80, v136, v137
    v_cvt_pk_bf16_f32 v81, v138, v139
    v_mfma_f32_16x16x32_bf16 v[184:187], v[36:39], v[200:203], v[184:187]
    v_cvt_pk_bf16_f32 v82, v140, v141
    v_cvt_pk_bf16_f32 v83, v142, v143
    v_mfma_f32_16x16x32_bf16 v[172:175], v[32:35], v[204:207], v[172:175]
    v_cvt_pk_bf16_f32 v84, v152, v153
    v_cvt_pk_bf16_f32 v85, v154, v155
    v_mfma_f32_16x16x32_bf16 v[188:191], v[36:39], v[204:207], v[188:191]
    v_cvt_pk_bf16_f32 v86, v156, v157
    v_cvt_pk_bf16_f32 v87, v158, v159
    v_permlane16_swap_b32 v72, v74
    v_permlane16_swap_b32 v73, v75
    v_permlane16_swap_b32 v76, v78
    v_permlane16_swap_b32 v77, v79
    v_permlane16_swap_b32 v80, v82
    v_permlane16_swap_b32 v81, v83
    v_permlane16_swap_b32 v84, v86
    v_permlane16_swap_b32 v85, v87
    v_mul_f32 v216, 0x3fb8aa3b, v216
    v_mul_f32 v218, 0x3fb8aa3b, v218
    v_mfma_f32_32x32x16_bf16 v[40:55], v[64:67], v[72:75], 0
    v_mul_f32 v160, v160, v208
    v_mul_f32 v161, v161, v208
    v_mul_f32 v162, v162, v208
    v_mul_f32 v163, v163, v208
    v_cvt_pk_bf16_f32 v160, v160, v161
    v_cvt_pk_bf16_f32 v161, v162, v163
    v_mfma_f32_32x32x16_bf16 v[40:55], v[68:71], v[76:79], v[40:55]
    v_mul_f32 v176, v176, v208
    v_mul_f32 v177, v177, v208
    v_mul_f32 v178, v178, v208
    v_mul_f32 v179, v179, v208
    v_cvt_pk_bf16_f32 v176, v176, v177
    v_cvt_pk_bf16_f32 v177, v178, v179
    v_mfma_f32_32x32x16_bf16 v[24:39], v[64:67], v[80:83], 0
    v_mul_f32 v164, v164, v210
    v_mul_f32 v165, v165, v210
    v_mul_f32 v166, v166, v210
    v_mul_f32 v167, v167, v210
    v_cvt_pk_bf16_f32 v164, v164, v165
    v_cvt_pk_bf16_f32 v165, v166, v167
    v_mfma_f32_32x32x16_bf16 v[24:39], v[68:71], v[84:87], v[24:39]
    v_mul_f32 v180, v180, v210
    v_mul_f32 v181, v181, v210
    v_mul_f32 v182, v182, v210
    v_mul_f32 v183, v183, v210
    v_cvt_pk_bf16_f32 v180, v180, v181
    v_cvt_pk_bf16_f32 v181, v182, v183
    v_mul_f32 v168, v168, v212
    v_mul_f32 v169, v169, v212
    v_mul_f32 v170, v170, v212
    v_mul_f32 v171, v171, v212
    v_cvt_pk_bf16_f32 v168, v168, v169
    v_cvt_pk_bf16_f32 v169, v170, v171
    v_pk_mul_f32 v[184:185], v[184:185], v[212:213] op_sel_hi:[1,0]
    v_pk_mul_f32 v[186:187], v[186:187], v[212:213] op_sel_hi:[1,0]
    v_cvt_pk_bf16_f32 v184, v184, v185
    v_cvt_pk_bf16_f32 v185, v186, v187
    v_pk_mul_f32 v[172:173], v[172:173], v[214:215] op_sel_hi:[1,0]
    v_pk_mul_f32 v[174:175], v[174:175], v[214:215] op_sel_hi:[1,0]
    v_cvt_pk_bf16_f32 v172, v172, v173
    v_cvt_pk_bf16_f32 v173, v174, v175
    v_pk_mul_f32 v[188:189], v[188:189], v[214:215] op_sel_hi:[1,0]
    v_pk_mul_f32 v[190:191], v[190:191], v[214:215] op_sel_hi:[1,0]
    v_cvt_pk_bf16_f32 v188, v188, v189
    v_cvt_pk_bf16_f32 v189, v190, v191
    v_xor_b32 v2, 16, v252
    v_xor_b32 v3, 32, v252
    v_xor_b32_e64 v4, 48, v252
    v_max3_f32 v222, v40, v41, v42
    v_min3_f32 v220, v40, v41, v42
    v_max3_f32 v222, v222, v43, v44
    v_min3_f32 v220, v220, v43, v44
    v_max3_f32 v222, v222, v45, v46
    v_min3_f32 v220, v220, v45, v46
    v_max3_f32 v222, v222, v47, v48
    v_min3_f32 v220, v220, v47, v48
    v_max3_f32 v222, v222, v49, v50
    v_min3_f32 v220, v220, v49, v50
    v_max3_f32 v222, v222, v51, v52
    v_min3_f32 v220, v220, v51, v52
    v_max3_f32 v222, v222, v53, v54
    v_min3_f32 v220, v220, v53, v54
    v_max_f32 v222, v222, v55
    v_min_f32 v220, v220, v55
    v_mul_f32 v222, v222, v216
    v_mul_f32 v220, v220, v216
    v_pk_fma_f32 v[72:73], v[40:41], v[216:217], v[222:223] op_sel_hi:[1,0,0] neg_lo:[0,0,1] neg_hi:[0,0,1]
    v_pk_fma_f32 v[40:41], v[40:41], v[216:217], v[220:221] op_sel_hi:[1,0,0] neg_lo:[1,0,0] neg_hi:[1,0,0]
    v_pk_fma_f32 v[74:75], v[42:43], v[216:217], v[222:223] op_sel_hi:[1,0,0] neg_lo:[0,0,1] neg_hi:[0,0,1]
    v_pk_fma_f32 v[42:43], v[42:43], v[216:217], v[220:221] op_sel_hi:[1,0,0] neg_lo:[1,0,0] neg_hi:[1,0,0]
    v_pk_fma_f32 v[76:77], v[44:45], v[216:217], v[222:223] op_sel_hi:[1,0,0] neg_lo:[0,0,1] neg_hi:[0,0,1]
    v_pk_fma_f32 v[44:45], v[44:45], v[216:217], v[220:221] op_sel_hi:[1,0,0] neg_lo:[1,0,0] neg_hi:[1,0,0]
    v_pk_fma_f32 v[78:79], v[46:47], v[216:217], v[222:223] op_sel_hi:[1,0,0] neg_lo:[0,0,1] neg_hi:[0,0,1]
    v_pk_fma_f32 v[46:47], v[46:47], v[216:217], v[220:221] op_sel_hi:[1,0,0] neg_lo:[1,0,0] neg_hi:[1,0,0]
    v_pk_fma_f32 v[80:81], v[48:49], v[216:217], v[222:223] op_sel_hi:[1,0,0] neg_lo:[0,0,1] neg_hi:[0,0,1]
    v_pk_fma_f32 v[48:49], v[48:49], v[216:217], v[220:221] op_sel_hi:[1,0,0] neg_lo:[1,0,0] neg_hi:[1,0,0]
    v_pk_fma_f32 v[82:83], v[50:51], v[216:217], v[222:223] op_sel_hi:[1,0,0] neg_lo:[0,0,1] neg_hi:[0,0,1]
    v_pk_fma_f32 v[50:51], v[50:51], v[216:217], v[220:221] op_sel_hi:[1,0,0] neg_lo:[1,0,0] neg_hi:[1,0,0]
    v_pk_fma_f32 v[84:85], v[52:53], v[216:217], v[222:223] op_sel_hi:[1,0,0] neg_lo:[0,0,1] neg_hi:[0,0,1]
    v_pk_fma_f32 v[52:53], v[52:53], v[216:217], v[220:221] op_sel_hi:[1,0,0] neg_lo:[1,0,0] neg_hi:[1,0,0]
    v_pk_fma_f32 v[86:87], v[54:55], v[216:217], v[222:223] op_sel_hi:[1,0,0] neg_lo:[0,0,1] neg_hi:[0,0,1]
    v_pk_fma_f32 v[54:55], v[54:55], v[216:217], v[220:221] op_sel_hi:[1,0,0] neg_lo:[1,0,0] neg_hi:[1,0,0]
    v_exp_f32 v72, v72
    v_exp_f32 v73, v73
    v_exp_f32 v74, v74
    v_exp_f32 v75, v75
    v_exp_f32 v76, v76
    v_exp_f32 v77, v77
    v_exp_f32 v78, v78
    v_exp_f32 v79, v79
    ds_write_b64 v253, v[160:161] offset:0
    v_exp_f32 v80, v80
    v_exp_f32 v81, v81
    v_exp_f32 v82, v82
    v_exp_f32 v83, v83
    v_exp_f32 v84, v84
    v_exp_f32 v85, v85
    v_exp_f32 v86, v86
    v_exp_f32 v87, v87
    ds_write_b64 v253, v[176:177] offset:4096
    v_exp_f32 v40, v40
    v_exp_f32 v41, v41
    v_exp_f32 v42, v42
    v_exp_f32 v43, v43
    v_exp_f32 v44, v44
    v_exp_f32 v45, v45
    v_exp_f32 v46, v46
    v_exp_f32 v47, v47
    ds_write_b64 v253, v[164:165] offset:512
    v_exp_f32 v48, v48
    v_exp_f32 v49, v49
    v_exp_f32 v50, v50
    v_exp_f32 v51, v51
    v_exp_f32 v52, v52
    v_exp_f32 v53, v53
    v_exp_f32 v54, v54
    v_exp_f32 v55, v55
    ds_write_b64 v253, v[180:181] offset:4608
    v_pk_add_f32 v[88:89], v[72:73], v[74:75]
    v_pk_add_f32 v[90:91], v[76:77], v[78:79]
    v_pk_add_f32 v[92:93], v[40:41], v[42:43]
    v_pk_add_f32 v[94:95], v[44:45], v[46:47]
    v_pk_add_f32 v[88:89], v[88:89], v[80:81]
    v_pk_add_f32 v[92:93], v[92:93], v[48:49]
    v_pk_add_f32 v[90:91], v[90:91], v[82:83]
    v_pk_add_f32 v[94:95], v[94:95], v[50:51]
    v_pk_add_f32 v[88:89], v[88:89], v[84:85]
    v_pk_add_f32 v[92:93], v[92:93], v[52:53]
    v_pk_add_f32 v[90:91], v[90:91], v[86:87]
    v_pk_add_f32 v[94:95], v[94:95], v[54:55]
    v_pk_add_f32 v[88:89], v[88:89], v[90:91]
    v_pk_add_f32 v[92:93], v[92:93], v[94:95]
    v_add_f32 v88, v88, v89
    v_add_f32 v92, v92, v93
    v_rcp_f32 v88, v88
    v_rcp_f32 v92, v92
    v_pk_mul_f32 v[72:73], v[72:73], v[88:89] op_sel_hi:[1,0]
    v_pk_mul_f32 v[74:75], v[74:75], v[88:89] op_sel_hi:[1,0]
    v_pk_mul_f32 v[76:77], v[76:77], v[88:89] op_sel_hi:[1,0]
    v_pk_mul_f32 v[78:79], v[78:79], v[88:89] op_sel_hi:[1,0]
    v_pk_mul_f32 v[80:81], v[80:81], v[88:89] op_sel_hi:[1,0]
    v_pk_mul_f32 v[82:83], v[82:83], v[88:89] op_sel_hi:[1,0]
    v_pk_mul_f32 v[84:85], v[84:85], v[88:89] op_sel_hi:[1,0]
    v_pk_mul_f32 v[86:87], v[86:87], v[88:89] op_sel_hi:[1,0]
    v_cvt_pk_bf16_f32 v128, v72, v73
    v_cvt_pk_bf16_f32 v129, v74, v75
    v_cvt_pk_bf16_f32 v130, v76, v77
    v_cvt_pk_bf16_f32 v131, v78, v79
    ds_write_b128 v252, v[128:131] offset:0
    v_cvt_pk_bf16_f32 v132, v80, v81
    v_cvt_pk_bf16_f32 v133, v82, v83
    v_cvt_pk_bf16_f32 v134, v84, v85
    v_cvt_pk_bf16_f32 v135, v86, v87
    ds_write_b128 v2, v[132:135] offset:0
    v_pk_mul_f32 v[40:41], v[40:41], v[92:93] op_sel_hi:[1,0]
    v_pk_mul_f32 v[42:43], v[42:43], v[92:93] op_sel_hi:[1,0]
    v_pk_mul_f32 v[44:45], v[44:45], v[92:93] op_sel_hi:[1,0]
    v_pk_mul_f32 v[46:47], v[46:47], v[92:93] op_sel_hi:[1,0]
    v_pk_mul_f32 v[48:49], v[48:49], v[92:93] op_sel_hi:[1,0]
    v_pk_mul_f32 v[50:51], v[50:51], v[92:93] op_sel_hi:[1,0]
    v_pk_mul_f32 v[52:53], v[52:53], v[92:93] op_sel_hi:[1,0]
    v_pk_mul_f32 v[54:55], v[54:55], v[92:93] op_sel_hi:[1,0]
    v_cvt_pk_bf16_f32 v136, v40, v41
    v_cvt_pk_bf16_f32 v137, v42, v43
    v_cvt_pk_bf16_f32 v138, v44, v45
    v_cvt_pk_bf16_f32 v139, v46, v47
    ds_write_b128 v3, v[136:139] offset:0
    v_cvt_pk_bf16_f32 v140, v48, v49
    v_cvt_pk_bf16_f32 v141, v50, v51
    v_cvt_pk_bf16_f32 v142, v52, v53
    v_cvt_pk_bf16_f32 v143, v54, v55
    ds_write_b128 v4, v[140:143] offset:0
    v_max3_f32 v222, v24, v25, v26
    v_min3_f32 v220, v24, v25, v26
    v_max3_f32 v222, v222, v27, v28
    v_min3_f32 v220, v220, v27, v28
    v_max3_f32 v222, v222, v29, v30
    v_min3_f32 v220, v220, v29, v30
    v_max3_f32 v222, v222, v31, v32
    v_min3_f32 v220, v220, v31, v32
    v_max3_f32 v222, v222, v33, v34
    v_min3_f32 v220, v220, v33, v34
    v_max3_f32 v222, v222, v35, v36
    v_min3_f32 v220, v220, v35, v36
    v_max3_f32 v222, v222, v37, v38
    v_min3_f32 v220, v220, v37, v38
    v_max_f32 v222, v222, v39
    v_min_f32 v220, v220, v39
    v_mul_f32 v222, v222, v218
    v_mul_f32 v220, v220, v218
    v_pk_fma_f32 v[72:73], v[24:25], v[218:219], v[222:223] op_sel_hi:[1,0,0] neg_lo:[0,0,1] neg_hi:[0,0,1]
    v_pk_fma_f32 v[24:25], v[24:25], v[218:219], v[220:221] op_sel_hi:[1,0,0] neg_lo:[1,0,0] neg_hi:[1,0,0]
    v_pk_fma_f32 v[74:75], v[26:27], v[218:219], v[222:223] op_sel_hi:[1,0,0] neg_lo:[0,0,1] neg_hi:[0,0,1]
    v_pk_fma_f32 v[26:27], v[26:27], v[218:219], v[220:221] op_sel_hi:[1,0,0] neg_lo:[1,0,0] neg_hi:[1,0,0]
    v_pk_fma_f32 v[76:77], v[28:29], v[218:219], v[222:223] op_sel_hi:[1,0,0] neg_lo:[0,0,1] neg_hi:[0,0,1]
    v_pk_fma_f32 v[28:29], v[28:29], v[218:219], v[220:221] op_sel_hi:[1,0,0] neg_lo:[1,0,0] neg_hi:[1,0,0]
    v_pk_fma_f32 v[78:79], v[30:31], v[218:219], v[222:223] op_sel_hi:[1,0,0] neg_lo:[0,0,1] neg_hi:[0,0,1]
    v_pk_fma_f32 v[30:31], v[30:31], v[218:219], v[220:221] op_sel_hi:[1,0,0] neg_lo:[1,0,0] neg_hi:[1,0,0]
    v_pk_fma_f32 v[80:81], v[32:33], v[218:219], v[222:223] op_sel_hi:[1,0,0] neg_lo:[0,0,1] neg_hi:[0,0,1]
    v_pk_fma_f32 v[32:33], v[32:33], v[218:219], v[220:221] op_sel_hi:[1,0,0] neg_lo:[1,0,0] neg_hi:[1,0,0]
    v_pk_fma_f32 v[82:83], v[34:35], v[218:219], v[222:223] op_sel_hi:[1,0,0] neg_lo:[0,0,1] neg_hi:[0,0,1]
    v_pk_fma_f32 v[34:35], v[34:35], v[218:219], v[220:221] op_sel_hi:[1,0,0] neg_lo:[1,0,0] neg_hi:[1,0,0]
    v_pk_fma_f32 v[84:85], v[36:37], v[218:219], v[222:223] op_sel_hi:[1,0,0] neg_lo:[0,0,1] neg_hi:[0,0,1]
    v_pk_fma_f32 v[36:37], v[36:37], v[218:219], v[220:221] op_sel_hi:[1,0,0] neg_lo:[1,0,0] neg_hi:[1,0,0]
    v_pk_fma_f32 v[86:87], v[38:39], v[218:219], v[222:223] op_sel_hi:[1,0,0] neg_lo:[0,0,1] neg_hi:[0,0,1]
    v_pk_fma_f32 v[38:39], v[38:39], v[218:219], v[220:221] op_sel_hi:[1,0,0] neg_lo:[1,0,0] neg_hi:[1,0,0]
    v_exp_f32 v72, v72
    v_exp_f32 v73, v73
    v_exp_f32 v74, v74
    v_exp_f32 v75, v75
    v_exp_f32 v76, v76
    v_exp_f32 v77, v77
    v_exp_f32 v78, v78
    v_exp_f32 v79, v79
    ds_write_b64 v253, v[168:169] offset:1024
    v_exp_f32 v80, v80
    v_exp_f32 v81, v81
    v_exp_f32 v82, v82
    v_exp_f32 v83, v83
    v_exp_f32 v84, v84
    v_exp_f32 v85, v85
    v_exp_f32 v86, v86
    v_exp_f32 v87, v87
    ds_write_b64 v253, v[184:185] offset:5120
    v_exp_f32 v24, v24
    v_exp_f32 v25, v25
    v_exp_f32 v26, v26
    v_exp_f32 v27, v27
    v_exp_f32 v28, v28
    v_exp_f32 v29, v29
    v_exp_f32 v30, v30
    v_exp_f32 v31, v31
    ds_write_b64 v253, v[172:173] offset:1536
    v_exp_f32 v32, v32
    v_exp_f32 v33, v33
    v_exp_f32 v34, v34
    v_exp_f32 v35, v35
    v_exp_f32 v36, v36
    v_exp_f32 v37, v37
    v_exp_f32 v38, v38
    v_exp_f32 v39, v39
    ds_write_b64 v253, v[188:189] offset:5632
    v_pk_add_f32 v[88:89], v[72:73], v[74:75]
    v_pk_add_f32 v[90:91], v[76:77], v[78:79]
    v_pk_add_f32 v[92:93], v[24:25], v[26:27]
    v_pk_add_f32 v[94:95], v[28:29], v[30:31]
    v_pk_add_f32 v[88:89], v[88:89], v[80:81]
    v_pk_add_f32 v[92:93], v[92:93], v[32:33]
    v_pk_add_f32 v[90:91], v[90:91], v[82:83]
    v_pk_add_f32 v[94:95], v[94:95], v[34:35]
    v_pk_add_f32 v[88:89], v[88:89], v[84:85]
    v_pk_add_f32 v[92:93], v[92:93], v[36:37]
    v_pk_add_f32 v[90:91], v[90:91], v[86:87]
    v_pk_add_f32 v[94:95], v[94:95], v[38:39]
    v_pk_add_f32 v[88:89], v[88:89], v[90:91]
    v_pk_add_f32 v[92:93], v[92:93], v[94:95]
    v_add_f32 v88, v88, v89
    v_add_f32 v92, v92, v93
    v_rcp_f32 v88, v88
    v_rcp_f32 v92, v92
    v_pk_mul_f32 v[72:73], v[72:73], v[88:89] op_sel_hi:[1,0]
    v_pk_mul_f32 v[74:75], v[74:75], v[88:89] op_sel_hi:[1,0]
    v_pk_mul_f32 v[76:77], v[76:77], v[88:89] op_sel_hi:[1,0]
    v_pk_mul_f32 v[78:79], v[78:79], v[88:89] op_sel_hi:[1,0]
    v_pk_mul_f32 v[80:81], v[80:81], v[88:89] op_sel_hi:[1,0]
    v_pk_mul_f32 v[82:83], v[82:83], v[88:89] op_sel_hi:[1,0]
    v_pk_mul_f32 v[84:85], v[84:85], v[88:89] op_sel_hi:[1,0]
    v_pk_mul_f32 v[86:87], v[86:87], v[88:89] op_sel_hi:[1,0]
    v_cvt_pk_bf16_f32 v144, v72, v73
    v_cvt_pk_bf16_f32 v145, v74, v75
    v_cvt_pk_bf16_f32 v146, v76, v77
    v_cvt_pk_bf16_f32 v147, v78, v79
    ds_write_b128 v252, v[144:147] offset:2048
    v_cvt_pk_bf16_f32 v148, v80, v81
    v_cvt_pk_bf16_f32 v149, v82, v83
    v_cvt_pk_bf16_f32 v150, v84, v85
    v_cvt_pk_bf16_f32 v151, v86, v87
    ds_write_b128 v2, v[148:151] offset:2048
    v_pk_mul_f32 v[24:25], v[24:25], v[92:93] op_sel_hi:[1,0]
    v_pk_mul_f32 v[26:27], v[26:27], v[92:93] op_sel_hi:[1,0]
    v_pk_mul_f32 v[28:29], v[28:29], v[92:93] op_sel_hi:[1,0]
    v_pk_mul_f32 v[30:31], v[30:31], v[92:93] op_sel_hi:[1,0]
    v_pk_mul_f32 v[32:33], v[32:33], v[92:93] op_sel_hi:[1,0]
    v_pk_mul_f32 v[34:35], v[34:35], v[92:93] op_sel_hi:[1,0]
    v_pk_mul_f32 v[36:37], v[36:37], v[92:93] op_sel_hi:[1,0]
    v_pk_mul_f32 v[38:39], v[38:39], v[92:93] op_sel_hi:[1,0]
    v_cvt_pk_bf16_f32 v152, v24, v25
    v_cvt_pk_bf16_f32 v153, v26, v27
    v_cvt_pk_bf16_f32 v154, v28, v29
    v_cvt_pk_bf16_f32 v155, v30, v31
    ds_write_b128 v3, v[152:155] offset:2048
    v_cvt_pk_bf16_f32 v156, v32, v33
    v_cvt_pk_bf16_f32 v157, v34, v35
    v_cvt_pk_bf16_f32 v158, v36, v37
    v_cvt_pk_bf16_f32 v159, v38, v39
    ds_write_b128 v4, v[156:159] offset:2048
    s_waitcnt lgkmcnt(0)
    s_setprio 0
    s_barrier
    buffer_load_dwordx4 v[240:243], v248, s[8:11], 0 offen
    buffer_load_dwordx4 v[244:247], v249, s[36:39], s51 offen
    v_mfma_f32_16x16x32_bf16 v[96:99], v[16:19], v[192:195], v[96:99]
    v_mfma_f32_16x16x32_bf16 v[112:115], v[20:23], v[192:195], v[112:115]
    v_mfma_f32_16x16x32_bf16 v[100:103], v[16:19], v[196:199], v[100:103]
    v_mfma_f32_16x16x32_bf16 v[116:119], v[20:23], v[196:199], v[116:119]
    v_mfma_f32_16x16x32_bf16 v[104:107], v[16:19], v[200:203], v[104:107]
    v_mfma_f32_16x16x32_bf16 v[120:123], v[20:23], v[200:203], v[120:123]
    v_mfma_f32_16x16x32_bf16 v[108:111], v[16:19], v[204:207], v[108:111]
    v_mfma_f32_16x16x32_bf16 v[124:127], v[20:23], v[204:207], v[124:127]
    s_nop 0
    v_cvt_pk_bf16_f32 v96, v96, v97
    v_cvt_pk_bf16_f32 v97, v98, v99
    ds_write_b64 v254, v[96:97] offset:0
    v_cvt_pk_bf16_f32 v100, v100, v101
    v_cvt_pk_bf16_f32 v101, v102, v103
    ds_write_b64 v254, v[100:101] offset:512
    v_cvt_pk_bf16_f32 v104, v104, v105
    v_cvt_pk_bf16_f32 v105, v106, v107
    ds_write_b64 v254, v[104:105] offset:1024
    v_cvt_pk_bf16_f32 v108, v108, v109
    v_cvt_pk_bf16_f32 v109, v110, v111
    ds_write_b64 v254, v[108:109] offset:1536
    v_cvt_pk_bf16_f32 v112, v112, v113
    v_cvt_pk_bf16_f32 v113, v114, v115
    ds_write_b64 v254, v[112:113] offset:4096
    v_cvt_pk_bf16_f32 v116, v116, v117
    v_cvt_pk_bf16_f32 v117, v118, v119
    ds_write_b64 v254, v[116:117] offset:4608
    v_cvt_pk_bf16_f32 v120, v120, v121
    v_cvt_pk_bf16_f32 v121, v122, v123
    ds_write_b64 v254, v[120:121] offset:5120
    v_cvt_pk_bf16_f32 v124, v124, v125
    v_cvt_pk_bf16_f32 v125, v126, v127
    ds_write_b64 v254, v[124:125] offset:5632
    s_waitcnt lgkmcnt(0)
    s_barrier
    s_add_u32 m0, s42, 32768
    s_add_u32 s6, s58, 2
    s_lshl_b32 s6, s6, 15
    s_add_u32 s6, s6, s51
    buffer_load_dwordx4 v224, s[20:23], s6 offen offset:0 lds
    buffer_load_dwordx4 v225, s[20:23], s6 offen offset:1024 lds
    buffer_load_dwordx4 v226, s[20:23], s6 offen offset:2048 lds
    buffer_load_dwordx4 v227, s[20:23], s6 offen offset:3072 lds
    s_barrier
    s_add_u32 m0, s42, 49152
    s_add_u32 s6, s59, 2
    s_lshl_b32 s6, s6, 15
    s_add_u32 s6, s6, s51
    buffer_load_dwordx4 v224, s[20:23], s6 offen offset:0 lds
    buffer_load_dwordx4 v225, s[20:23], s6 offen offset:1024 lds
    buffer_load_dwordx4 v226, s[20:23], s6 offen offset:2048 lds
    buffer_load_dwordx4 v227, s[20:23], s6 offen offset:3072 lds
    s_add_u32 s4, s49, 0
    s_mov_b64 exec, 0xf
    buffer_load_dword v235, v232, s[16:19], s4 offen sc1
    s_mov_b64 exec, -1
    s_add_u32 m0, s42, 65536
    s_add_u32 s6, s44, 4
    s_lshl_b32 s6, s6, 15
    s_add_u32 s6, s6, s51
    buffer_load_dwordx4 v224, s[20:23], s6 offen offset:0 lds
    buffer_load_dwordx4 v225, s[20:23], s6 offen offset:1024 lds
    buffer_load_dwordx4 v226, s[20:23], s6 offen offset:2048 lds
    buffer_load_dwordx4 v227, s[20:23], s6 offen offset:3072 lds
    s_add_u32 m0, s42, 147456
    s_add_u32 s6, s45, 4
    s_lshl_b32 s6, s6, 15
    s_add_u32 s6, s6, s51
    buffer_load_dwordx4 v224, s[20:23], s6 offen offset:0 lds
    buffer_load_dwordx4 v225, s[20:23], s6 offen offset:1024 lds
    buffer_load_dwordx4 v226, s[20:23], s6 offen offset:2048 lds
    buffer_load_dwordx4 v227, s[20:23], s6 offen offset:3072 lds
    s_waitcnt vmcnt(8)
    v_cmp_ne_u32 vcc, s68, v235
    s_nop 0
    s_and_b64 vcc, vcc, 0xf
    s_cbranch_scc0 L_pk_18
    s_add_u32 s4, s49, 0
    s_mov_b64 exec, 0xf
    s_mov_b32 s7, 0
L_poll_19:
    buffer_load_dword v235, v232, s[16:19], s4 offen offset:0 sc1
    s_add_u32 s7, s7, 1
    s_cmp_gt_u32 s7, 200000
    s_cbranch_scc1 L_polld_20
    s_waitcnt vmcnt(0)
    v_cmp_ne_u32 vcc, s68, v235
    s_nop 0
    s_cbranch_vccz L_polld_20
    s_sleep 6
    s_branch L_poll_19
L_polld_20:
    s_waitcnt vmcnt(0)
    s_mov_b64 exec, -1
L_pk_18:
L_ph2:
    v_add_u32 v2, 65536, v236
    v_add_u32 v3, 65536, v237
    v_add_u32 v4, 65536, v238
    v_add_u32 v5, 65536, v239
    v_add_u32 v6, 131072, v236
    v_add_u32 v7, 131072, v237
    v_add_u32 v8, 131072, v238
    v_add_u32 v9, 131072, v239
    s_cmp_eq_u32 s67, 3
    s_cselect_b64 s[72:73], 1, -1
    s_mov_b64 s[0:1], -1
    s_mov_b32 s3, 0
    s_add_u32 s6, s56, 0
    s_lshl_b32 s6, s6, 12
    s_add_u32 s6, s6, s46
    buffer_load_dwordx4 v[104:107], v251, s[16:19], s6 offen offset:0 sc1
    buffer_load_dwordx4 v[108:111], v251, s[16:19], s6 offen offset:1024 sc1
    buffer_load_dwordx4 v[112:115], v251, s[16:19], s6 offen offset:2048 sc1
    buffer_load_dwordx4 v[116:119], v251, s[16:19], s6 offen offset:3072 sc1
    s_add_u32 s6, s57, 0
    s_lshl_b32 s6, s6, 12
    s_add_u32 s6, s6, s46
    buffer_load_dwordx4 v[120:123], v251, s[16:19], s6 offen offset:0 sc1
    buffer_load_dwordx4 v[124:127], v251, s[16:19], s6 offen offset:1024 sc1
    buffer_load_dwordx4 v[128:131], v251, s[16:19], s6 offen offset:2048 sc1
    buffer_load_dwordx4 v[132:135], v251, s[16:19], s6 offen offset:3072 sc1
    s_add_u32 s4, s49, 2048
    s_mov_b64 exec, 0xf
    buffer_load_dword v235, v232, s[16:19], s4 offen sc1
    s_mov_b64 exec, -1
    ds_read_b64_tr_b16 v[16:17], v6 offset:0
    ds_read_b64_tr_b16 v[18:19], v6 offset:512
    ds_read_b64_tr_b16 v[20:21], v2 offset:16384
    ds_read_b64_tr_b16 v[22:23], v2 offset:16896
    ds_read_b64_tr_b16 v[24:25], v7 offset:0
    ds_read_b64_tr_b16 v[26:27], v7 offset:512
    ds_read_b64_tr_b16 v[28:29], v3 offset:16384
    ds_read_b64_tr_b16 v[30:31], v3 offset:16896
    s_add_u32 s6, s58, 0
    s_lshl_b32 s6, s6, 12
    s_add_u32 s6, s6, s46
    buffer_load_dwordx4 v[136:139], v251, s[16:19], s6 offen offset:0 sc1
    buffer_load_dwordx4 v[140:143], v251, s[16:19], s6 offen offset:1024 sc1
    buffer_load_dwordx4 v[144:147], v251, s[16:19], s6 offen offset:2048 sc1
    buffer_load_dwordx4 v[148:151], v251, s[16:19], s6 offen offset:3072 sc1
    s_add_u32 s6, s59, 0
    s_lshl_b32 s6, s6, 12
    s_add_u32 s6, s6, s46
    buffer_load_dwordx4 v[152:155], v251, s[16:19], s6 offen offset:0 sc1
    buffer_load_dwordx4 v[156:159], v251, s[16:19], s6 offen offset:1024 sc1
    buffer_load_dwordx4 v[160:163], v251, s[16:19], s6 offen offset:2048 sc1
    buffer_load_dwordx4 v[164:167], v251, s[16:19], s6 offen offset:3072 sc1
    s_xor_b32 s6, s79, 0
    s_lshl2_add_u32 s6, s67, s6
    s_lshl_b32 s6, s6, 12
    s_add_u32 s6, s6, s46
    s_add_u32 s52, s6, 180224
    s_xor_b32 s6, s79, 1
    s_lshl2_add_u32 s6, s67, s6
    s_lshl_b32 s6, s6, 12
    s_add_u32 s6, s6, s46
    s_add_u32 s53, s6, 180224
    s_xor_b32 s6, s79, 2
    s_lshl2_add_u32 s6, s67, s6
    s_lshl_b32 s6, s6, 12
    s_add_u32 s6, s6, s46
    s_add_u32 s54, s6, 180224
    s_xor_b32 s6, s79, 3
    s_lshl2_add_u32 s6, s67, s6
    s_lshl_b32 s6, s6, 12
    s_add_u32 s6, s6, s46
    s_add_u32 s55, s6, 180224
    v_lshlrev_b32_e64 v200, 16, v240
    v_and_b32 v201, 0xffff0000, v240
    v_lshlrev_b32_e64 v208, 16, v244
    v_and_b32 v209, 0xffff0000, v244
    v_lshlrev_b32_e64 v202, 16, v241
    v_and_b32 v203, 0xffff0000, v241
    v_lshlrev_b32_e64 v210, 16, v245
    v_and_b32 v211, 0xffff0000, v245
    v_lshlrev_b32_e64 v204, 16, v242
    v_and_b32 v205, 0xffff0000, v242
    v_lshlrev_b32_e64 v212, 16, v246
    v_and_b32 v213, 0xffff0000, v246
    v_lshlrev_b32_e64 v206, 16, v243
    v_and_b32 v207, 0xffff0000, v243
    v_lshlrev_b32_e64 v214, 16, v247
    v_and_b32 v215, 0xffff0000, v247
    v_pk_add_f32 v[240:241], v[200:201], v[208:209]
    v_pk_add_f32 v[242:243], v[202:203], v[210:211]
    v_pk_add_f32 v[244:245], v[204:205], v[212:213]
    v_pk_add_f32 v[246:247], v[206:207], v[214:215]
    s_cmp_eq_u32 s62, 0
    s_cbranch_scc1 L_sa_21
    s_barrier
    s_branch L_se_22
L_sa_21:
    s_waitcnt vmcnt(8)
    v_cmp_ne_u32 vcc, s68, v235
    s_nop 0
    s_and_b64 vcc, vcc, 0xf
    s_cbranch_scc0 L_pk_23
    s_add_u32 s4, s49, 2048
    s_mov_b64 exec, 0xf
    s_mov_b32 s7, 0
L_poll_24:
    buffer_load_dword v235, v232, s[16:19], s4 offen offset:0 sc1
    s_add_u32 s7, s7, 1
    s_cmp_gt_u32 s7, 200000
    s_cbranch_scc1 L_polld_25
    s_waitcnt vmcnt(0)
    v_cmp_ne_u32 vcc, s68, v235
    s_nop 0
    s_cbranch_vccz L_polld_25
    s_sleep 6
    s_branch L_poll_24
L_polld_25:
    s_waitcnt vmcnt(0)
    s_mov_b64 exec, -1
L_pk_23:
L_se_22:
    s_waitcnt vmcnt(9)
    s_waitcnt lgkmcnt(4)
    v_mfma_f32_16x16x32_bf16 v[40:43], v[104:107], v[16:19], 0
    ds_read_b64_tr_b16 v[32:33], v8 offset:0
    v_mfma_f32_16x16x32_bf16 v[40:43], v[120:123], v[20:23], v[40:43]
    ds_read_b64_tr_b16 v[34:35], v8 offset:512
    v_mfma_f32_16x16x32_bf16 v[44:47], v[108:111], v[16:19], 0
    ds_read_b64_tr_b16 v[36:37], v4 offset:16384
    v_mfma_f32_16x16x32_bf16 v[44:47], v[124:127], v[20:23], v[44:47]
    ds_read_b64_tr_b16 v[38:39], v4 offset:16896
    s_add_u32 s6, s56, 2
    s_lshl_b32 s6, s6, 12
    s_add_u32 s6, s6, s46
    buffer_load_dwordx4 v[168:171], v251, s[16:19], s6 offen offset:0 sc1
    v_mfma_f32_16x16x32_bf16 v[48:51], v[112:115], v[16:19], 0
    v_mfma_f32_16x16x32_bf16 v[48:51], v[128:131], v[20:23], v[48:51]
    v_mfma_f32_16x16x32_bf16 v[52:55], v[116:119], v[16:19], 0
    v_mfma_f32_16x16x32_bf16 v[52:55], v[132:135], v[20:23], v[52:55]
    buffer_load_dwordx4 v[172:175], v251, s[16:19], s6 offen offset:1024 sc1
    s_waitcnt lgkmcnt(4)
    v_mfma_f32_16x16x32_bf16 v[56:59], v[104:107], v[24:27], 0
    ds_read_b64_tr_b16 v[16:17], v9 offset:0
    v_mfma_f32_16x16x32_bf16 v[56:59], v[120:123], v[28:31], v[56:59]
    ds_read_b64_tr_b16 v[18:19], v9 offset:512
    v_mfma_f32_16x16x32_bf16 v[60:63], v[108:111], v[24:27], 0
    ds_read_b64_tr_b16 v[20:21], v5 offset:16384
    v_mfma_f32_16x16x32_bf16 v[60:63], v[124:127], v[28:31], v[60:63]
    ds_read_b64_tr_b16 v[22:23], v5 offset:16896
    buffer_load_dwordx4 v[176:179], v251, s[16:19], s6 offen offset:2048 sc1
    v_mfma_f32_16x16x32_bf16 v[64:67], v[112:115], v[24:27], 0
    v_mfma_f32_16x16x32_bf16 v[64:67], v[128:131], v[28:31], v[64:67]
    v_mfma_f32_16x16x32_bf16 v[68:71], v[116:119], v[24:27], 0
    v_mfma_f32_16x16x32_bf16 v[68:71], v[132:135], v[28:31], v[68:71]
    buffer_load_dwordx4 v[180:183], v251, s[16:19], s6 offen offset:3072 sc1
    s_waitcnt lgkmcnt(4)
    v_mfma_f32_16x16x32_bf16 v[72:75], v[104:107], v[32:35], 0
    ds_read_b64_tr_b16 v[24:25], v2 offset:32768
    v_mfma_f32_16x16x32_bf16 v[72:75], v[120:123], v[36:39], v[72:75]
    ds_read_b64_tr_b16 v[26:27], v2 offset:33280
    v_mfma_f32_16x16x32_bf16 v[76:79], v[108:111], v[32:35], 0
    ds_read_b64_tr_b16 v[28:29], v2 offset:49152
    v_mfma_f32_16x16x32_bf16 v[76:79], v[124:127], v[36:39], v[76:79]
    ds_read_b64_tr_b16 v[30:31], v2 offset:49664
    s_add_u32 s6, s57, 2
    s_lshl_b32 s6, s6, 12
    s_add_u32 s6, s6, s46
    buffer_load_dwordx4 v[184:187], v251, s[16:19], s6 offen offset:0 sc1
    v_mfma_f32_16x16x32_bf16 v[80:83], v[112:115], v[32:35], 0
    v_mfma_f32_16x16x32_bf16 v[80:83], v[128:131], v[36:39], v[80:83]
    v_mfma_f32_16x16x32_bf16 v[84:87], v[116:119], v[32:35], 0
    v_mfma_f32_16x16x32_bf16 v[84:87], v[132:135], v[36:39], v[84:87]
    buffer_load_dwordx4 v[188:191], v251, s[16:19], s6 offen offset:1024 sc1
    s_waitcnt lgkmcnt(4)
    v_mfma_f32_16x16x32_bf16 v[88:91], v[104:107], v[16:19], 0
    ds_read_b64_tr_b16 v[32:33], v3 offset:32768
    v_mfma_f32_16x16x32_bf16 v[88:91], v[120:123], v[20:23], v[88:91]
    ds_read_b64_tr_b16 v[34:35], v3 offset:33280
    v_mfma_f32_16x16x32_bf16 v[92:95], v[108:111], v[16:19], 0
    ds_read_b64_tr_b16 v[36:37], v3 offset:49152
    v_mfma_f32_16x16x32_bf16 v[92:95], v[124:127], v[20:23], v[92:95]
    ds_read_b64_tr_b16 v[38:39], v3 offset:49664
    buffer_load_dwordx4 v[192:195], v251, s[16:19], s6 offen offset:2048 sc1
    v_mfma_f32_16x16x32_bf16 v[96:99], v[112:115], v[16:19], 0
    v_mfma_f32_16x16x32_bf16 v[96:99], v[128:131], v[20:23], v[96:99]
    v_mfma_f32_16x16x32_bf16 v[100:103], v[116:119], v[16:19], 0
    v_mfma_f32_16x16x32_bf16 v[100:103], v[132:135], v[20:23], v[100:103]
    buffer_load_dwordx4 v[196:199], v251, s[16:19], s6 offen offset:3072 sc1
    s_waitcnt vmcnt(8)
    s_waitcnt lgkmcnt(4)
    v_mfma_f32_16x16x32_bf16 v[40:43], v[136:139], v[24:27], v[40:43]
    ds_read_b64_tr_b16 v[16:17], v4 offset:32768
    v_mfma_f32_16x16x32_bf16 v[40:43], v[152:155], v[28:31], v[40:43]
    ds_read_b64_tr_b16 v[18:19], v4 offset:33280
    v_mfma_f32_16x16x32_bf16 v[44:47], v[140:143], v[24:27], v[44:47]
    ds_read_b64_tr_b16 v[20:21], v4 offset:49152
    v_mfma_f32_16x16x32_bf16 v[44:47], v[156:159], v[28:31], v[44:47]
    ds_read_b64_tr_b16 v[22:23], v4 offset:49664
    s_add_u32 s6, s58, 2
    s_lshl_b32 s6, s6, 12
    s_add_u32 s6, s6, s46
    buffer_load_dwordx4 v[104:107], v251, s[16:19], s6 offen offset:0 sc1
    v_mfma_f32_16x16x32_bf16 v[48:51], v[144:147], v[24:27], v[48:51]
    v_mfma_f32_16x16x32_bf16 v[48:51], v[160:163], v[28:31], v[48:51]
    v_mfma_f32_16x16x32_bf16 v[52:55], v[148:151], v[24:27], v[52:55]
    v_mfma_f32_16x16x32_bf16 v[52:55], v[164:167], v[28:31], v[52:55]
    buffer_load_dwordx4 v[108:111], v251, s[16:19], s6 offen offset:1024 sc1
    s_waitcnt lgkmcnt(4)
    v_mfma_f32_16x16x32_bf16 v[56:59], v[136:139], v[32:35], v[56:59]
    ds_read_b64_tr_b16 v[24:25], v5 offset:32768
    v_mfma_f32_16x16x32_bf16 v[56:59], v[152:155], v[36:39], v[56:59]
    ds_read_b64_tr_b16 v[26:27], v5 offset:33280
    v_mfma_f32_16x16x32_bf16 v[60:63], v[140:143], v[32:35], v[60:63]
    ds_read_b64_tr_b16 v[28:29], v5 offset:49152
    v_mfma_f32_16x16x32_bf16 v[60:63], v[156:159], v[36:39], v[60:63]
    ds_read_b64_tr_b16 v[30:31], v5 offset:49664
    buffer_load_dwordx4 v[112:115], v251, s[16:19], s6 offen offset:2048 sc1
    v_mfma_f32_16x16x32_bf16 v[64:67], v[144:147], v[32:35], v[64:67]
    v_mfma_f32_16x16x32_bf16 v[64:67], v[160:163], v[36:39], v[64:67]
    v_mfma_f32_16x16x32_bf16 v[68:71], v[148:151], v[32:35], v[68:71]
    v_mfma_f32_16x16x32_bf16 v[68:71], v[164:167], v[36:39], v[68:71]
    buffer_load_dwordx4 v[116:119], v251, s[16:19], s6 offen offset:3072 sc1
    s_waitcnt lgkmcnt(4)
    v_mfma_f32_16x16x32_bf16 v[72:75], v[136:139], v[16:19], v[72:75]
    ds_read_b64_tr_b16 v[32:33], v236 offset:0
    v_mfma_f32_16x16x32_bf16 v[72:75], v[152:155], v[20:23], v[72:75]
    ds_read_b64_tr_b16 v[34:35], v236 offset:512
    v_mfma_f32_16x16x32_bf16 v[76:79], v[140:143], v[16:19], v[76:79]
    ds_read_b64_tr_b16 v[36:37], v236 offset:16384
    v_mfma_f32_16x16x32_bf16 v[76:79], v[156:159], v[20:23], v[76:79]
    ds_read_b64_tr_b16 v[38:39], v236 offset:16896
    s_add_u32 s6, s59, 2
    s_lshl_b32 s6, s6, 12
    s_add_u32 s6, s6, s46
    buffer_load_dwordx4 v[120:123], v251, s[16:19], s6 offen offset:0 sc1
    v_mfma_f32_16x16x32_bf16 v[80:83], v[144:147], v[16:19], v[80:83]
    v_mfma_f32_16x16x32_bf16 v[80:83], v[160:163], v[20:23], v[80:83]
    v_mfma_f32_16x16x32_bf16 v[84:87], v[148:151], v[16:19], v[84:87]
    v_mfma_f32_16x16x32_bf16 v[84:87], v[164:167], v[20:23], v[84:87]
    buffer_load_dwordx4 v[124:127], v251, s[16:19], s6 offen offset:1024 sc1
    s_waitcnt lgkmcnt(4)
    v_mfma_f32_16x16x32_bf16 v[88:91], v[136:139], v[24:27], v[88:91]
    ds_read_b64_tr_b16 v[16:17], v237 offset:0
    v_mfma_f32_16x16x32_bf16 v[88:91], v[152:155], v[28:31], v[88:91]
    ds_read_b64_tr_b16 v[18:19], v237 offset:512
    v_mfma_f32_16x16x32_bf16 v[92:95], v[140:143], v[24:27], v[92:95]
    ds_read_b64_tr_b16 v[20:21], v237 offset:16384
    v_mfma_f32_16x16x32_bf16 v[92:95], v[156:159], v[28:31], v[92:95]
    ds_read_b64_tr_b16 v[22:23], v237 offset:16896
    buffer_load_dwordx4 v[128:131], v251, s[16:19], s6 offen offset:2048 sc1
    v_mfma_f32_16x16x32_bf16 v[96:99], v[144:147], v[24:27], v[96:99]
    v_mfma_f32_16x16x32_bf16 v[96:99], v[160:163], v[28:31], v[96:99]
    v_mfma_f32_16x16x32_bf16 v[100:103], v[148:151], v[24:27], v[100:103]
    v_mfma_f32_16x16x32_bf16 v[100:103], v[164:167], v[28:31], v[100:103]
    buffer_load_dwordx4 v[132:135], v251, s[16:19], s6 offen offset:3072 sc1
    s_waitcnt vmcnt(8)
    s_waitcnt lgkmcnt(4)
    v_mfma_f32_16x16x32_bf16 v[40:43], v[168:171], v[32:35], v[40:43]
    ds_read_b64_tr_b16 v[24:25], v238 offset:0
    v_mfma_f32_16x16x32_bf16 v[40:43], v[184:187], v[36:39], v[40:43]
    ds_read_b64_tr_b16 v[26:27], v238 offset:512
    v_mfma_f32_16x16x32_bf16 v[44:47], v[172:175], v[32:35], v[44:47]
    ds_read_b64_tr_b16 v[28:29], v238 offset:16384
    v_mfma_f32_16x16x32_bf16 v[44:47], v[188:191], v[36:39], v[44:47]
    ds_read_b64_tr_b16 v[30:31], v238 offset:16896
    s_mov_b64 exec, s[72:73]
    s_add_u32 m0, s42, 131072
    s_add_u32 s6, s44, 5
    s_lshl_b32 s6, s6, 15
    s_add_u32 s6, s6, s51
    buffer_load_dwordx4 v224, s[20:23], s6 offen offset:0 lds
    s_mov_b64 exec, -1
    v_mfma_f32_16x16x32_bf16 v[48:51], v[176:179], v[32:35], v[48:51]
    v_mfma_f32_16x16x32_bf16 v[48:51], v[192:195], v[36:39], v[48:51]
    v_mfma_f32_16x16x32_bf16 v[52:55], v[180:183], v[32:35], v[52:55]
    v_mfma_f32_16x16x32_bf16 v[52:55], v[196:199], v[36:39], v[52:55]
    s_mov_b64 exec, s[72:73]
    buffer_load_dwordx4 v225, s[20:23], s6 offen offset:1024 lds
    s_mov_b64 exec, -1
    s_waitcnt lgkmcnt(4)
    v_mfma_f32_16x16x32_bf16 v[56:59], v[168:171], v[16:19], v[56:59]
    ds_read_b64_tr_b16 v[32:33], v239 offset:0
    v_mfma_f32_16x16x32_bf16 v[56:59], v[184:187], v[20:23], v[56:59]
    ds_read_b64_tr_b16 v[34:35], v239 offset:512
    v_mfma_f32_16x16x32_bf16 v[60:63], v[172:175], v[16:19], v[60:63]
    ds_read_b64_tr_b16 v[36:37], v239 offset:16384
    v_mfma_f32_16x16x32_bf16 v[60:63], v[188:191], v[20:23], v[60:63]
    ds_read_b64_tr_b16 v[38:39], v239 offset:16896
    s_mov_b64 exec, s[72:73]
    buffer_load_dwordx4 v226, s[20:23], s6 offen offset:2048 lds
    s_mov_b64 exec, -1
    v_mfma_f32_16x16x32_bf16 v[64:67], v[176:179], v[16:19], v[64:67]
    v_mfma_f32_16x16x32_bf16 v[64:67], v[192:195], v[20:23], v[64:67]
    v_mfma_f32_16x16x32_bf16 v[68:71], v[180:183], v[16:19], v[68:71]
    v_mfma_f32_16x16x32_bf16 v[68:71], v[196:199], v[20:23], v[68:71]
    s_mov_b64 exec, s[72:73]
    buffer_load_dwordx4 v227, s[20:23], s6 offen offset:3072 lds
    s_mov_b64 exec, -1
    s_waitcnt lgkmcnt(4)
    v_mfma_f32_16x16x32_bf16 v[72:75], v[168:171], v[24:27], v[72:75]
    ds_read_b64_tr_b16 v[16:17], v236 offset:32768
    v_mfma_f32_16x16x32_bf16 v[72:75], v[184:187], v[28:31], v[72:75]
    ds_read_b64_tr_b16 v[18:19], v236 offset:33280
    v_mfma_f32_16x16x32_bf16 v[76:79], v[172:175], v[24:27], v[76:79]
    ds_read_b64_tr_b16 v[20:21], v236 offset:49152
    v_mfma_f32_16x16x32_bf16 v[76:79], v[188:191], v[28:31], v[76:79]
    ds_read_b64_tr_b16 v[22:23], v236 offset:49664
    s_add_u32 s4, s49, 4096
    s_mov_b64 exec, 0xf
    buffer_load_dword v235, v232, s[16:19], s4 offen sc1
    s_mov_b64 exec, -1
    v_mfma_f32_16x16x32_bf16 v[80:83], v[176:179], v[24:27], v[80:83]
    v_mfma_f32_16x16x32_bf16 v[80:83], v[192:195], v[28:31], v[80:83]
    v_mfma_f32_16x16x32_bf16 v[84:87], v[180:183], v[24:27], v[84:87]
    v_mfma_f32_16x16x32_bf16 v[84:87], v[196:199], v[28:31], v[84:87]
    s_add_u32 m0, s42, 81920
    s_xor_b32 s6, s79, 0
    s_lshl2_add_u32 s6, s67, s6
    s_lshl_b32 s6, s6, 15
    s_add_u32 s6, s6, s51
    buffer_load_dwordx4 v228, s[24:27], s6 offen offset:0 lds
    buffer_load_dwordx4 v229, s[24:27], s6 offen offset:1024 lds
    s_waitcnt lgkmcnt(4)
    v_mfma_f32_16x16x32_bf16 v[88:91], v[168:171], v[32:35], v[88:91]
    ds_read_b64_tr_b16 v[24:25], v237 offset:32768
    v_mfma_f32_16x16x32_bf16 v[88:91], v[184:187], v[36:39], v[88:91]
    ds_read_b64_tr_b16 v[26:27], v237 offset:33280
    v_mfma_f32_16x16x32_bf16 v[92:95], v[172:175], v[32:35], v[92:95]
    ds_read_b64_tr_b16 v[28:29], v237 offset:49152
    v_mfma_f32_16x16x32_bf16 v[92:95], v[188:191], v[36:39], v[92:95]
    ds_read_b64_tr_b16 v[30:31], v237 offset:49664
    buffer_load_dwordx4 v230, s[24:27], s6 offen offset:2048 lds
    v_mfma_f32_16x16x32_bf16 v[96:99], v[176:179], v[32:35], v[96:99]
    v_mfma_f32_16x16x32_bf16 v[96:99], v[192:195], v[36:39], v[96:99]
    v_mfma_f32_16x16x32_bf16 v[100:103], v[180:183], v[32:35], v[100:103]
    v_mfma_f32_16x16x32_bf16 v[100:103], v[196:199], v[36:39], v[100:103]
    buffer_load_dwordx4 v231, s[24:27], s6 offen offset:3072 lds
    s_waitcnt vmcnt(9)
    s_waitcnt lgkmcnt(4)
    v_mfma_f32_16x16x32_bf16 v[40:43], v[104:107], v[16:19], v[40:43]
    ds_read_b64_tr_b16 v[32:33], v238 offset:32768
    v_mfma_f32_16x16x32_bf16 v[40:43], v[120:123], v[20:23], v[40:43]
    ds_read_b64_tr_b16 v[34:35], v238 offset:33280
    v_mfma_f32_16x16x32_bf16 v[44:47], v[108:111], v[16:19], v[44:47]
    ds_read_b64_tr_b16 v[36:37], v238 offset:49152
    v_mfma_f32_16x16x32_bf16 v[44:47], v[124:127], v[20:23], v[44:47]
    ds_read_b64_tr_b16 v[38:39], v238 offset:49664
    s_add_u32 m0, s42, 98304
    s_xor_b32 s6, s79, 1
    s_lshl2_add_u32 s6, s67, s6
    s_lshl_b32 s6, s6, 15
    s_add_u32 s6, s6, s51
    buffer_load_dwordx4 v228, s[24:27], s6 offen offset:0 lds
    v_mfma_f32_16x16x32_bf16 v[48:51], v[112:115], v[16:19], v[48:51]
    v_mfma_f32_16x16x32_bf16 v[48:51], v[128:131], v[20:23], v[48:51]
    v_mfma_f32_16x16x32_bf16 v[52:55], v[116:119], v[16:19], v[52:55]
    v_mfma_f32_16x16x32_bf16 v[52:55], v[132:135], v[20:23], v[52:55]
    buffer_load_dwordx4 v229, s[24:27], s6 offen offset:1024 lds
    s_waitcnt lgkmcnt(4)
    v_mfma_f32_16x16x32_bf16 v[56:59], v[104:107], v[24:27], v[56:59]
    ds_read_b64_tr_b16 v[16:17], v239 offset:32768
    v_mfma_f32_16x16x32_bf16 v[56:59], v[120:123], v[28:31], v[56:59]
    ds_read_b64_tr_b16 v[18:19], v239 offset:33280
    v_mfma_f32_16x16x32_bf16 v[60:63], v[108:111], v[24:27], v[60:63]
    ds_read_b64_tr_b16 v[20:21], v239 offset:49152
    v_mfma_f32_16x16x32_bf16 v[60:63], v[124:127], v[28:31], v[60:63]
    ds_read_b64_tr_b16 v[22:23], v239 offset:49664
    buffer_load_dwordx4 v230, s[24:27], s6 offen offset:2048 lds
    v_mfma_f32_16x16x32_bf16 v[64:67], v[112:115], v[24:27], v[64:67]
    v_mfma_f32_16x16x32_bf16 v[64:67], v[128:131], v[28:31], v[64:67]
    v_mfma_f32_16x16x32_bf16 v[68:71], v[116:119], v[24:27], v[68:71]
    v_mfma_f32_16x16x32_bf16 v[68:71], v[132:135], v[28:31], v[68:71]
    buffer_load_dwordx4 v231, s[24:27], s6 offen offset:3072 lds
    s_waitcnt lgkmcnt(4)
    v_mfma_f32_16x16x32_bf16 v[72:75], v[104:107], v[32:35], v[72:75]
    ds_read_b64_tr_b16 v[24:25], v2 offset:0
    v_mfma_f32_16x16x32_bf16 v[72:75], v[120:123], v[36:39], v[72:75]
    ds_read_b64_tr_b16 v[26:27], v2 offset:512
    v_mfma_f32_16x16x32_bf16 v[76:79], v[108:111], v[32:35], v[76:79]
    ds_read_b64_tr_b16 v[28:29], v6 offset:16384
    v_mfma_f32_16x16x32_bf16 v[76:79], v[124:127], v[36:39], v[76:79]
    ds_read_b64_tr_b16 v[30:31], v6 offset:16896
    s_add_u32 m0, s42, 114688
    s_xor_b32 s6, s79, 2
    s_lshl2_add_u32 s6, s67, s6
    s_lshl_b32 s6, s6, 15
    s_add_u32 s6, s6, s51
    buffer_load_dwordx4 v228, s[24:27], s6 offen offset:0 lds
    v_mfma_f32_16x16x32_bf16 v[80:83], v[112:115], v[32:35], v[80:83]
    v_mfma_f32_16x16x32_bf16 v[80:83], v[128:131], v[36:39], v[80:83]
    v_mfma_f32_16x16x32_bf16 v[84:87], v[116:119], v[32:35], v[84:87]
    v_mfma_f32_16x16x32_bf16 v[84:87], v[132:135], v[36:39], v[84:87]
    buffer_load_dwordx4 v229, s[24:27], s6 offen offset:1024 lds
    s_waitcnt lgkmcnt(4)
    v_mfma_f32_16x16x32_bf16 v[88:91], v[104:107], v[16:19], v[88:91]
    ds_read_b64_tr_b16 v[32:33], v3 offset:0
    v_mfma_f32_16x16x32_bf16 v[88:91], v[120:123], v[20:23], v[88:91]
    ds_read_b64_tr_b16 v[34:35], v3 offset:512
    v_mfma_f32_16x16x32_bf16 v[92:95], v[108:111], v[16:19], v[92:95]
    ds_read_b64_tr_b16 v[36:37], v7 offset:16384
    v_mfma_f32_16x16x32_bf16 v[92:95], v[124:127], v[20:23], v[92:95]
    ds_read_b64_tr_b16 v[38:39], v7 offset:16896
    buffer_load_dwordx4 v230, s[24:27], s6 offen offset:2048 lds
    v_mfma_f32_16x16x32_bf16 v[96:99], v[112:115], v[16:19], v[96:99]
    v_mfma_f32_16x16x32_bf16 v[96:99], v[128:131], v[20:23], v[96:99]
    v_mfma_f32_16x16x32_bf16 v[100:103], v[116:119], v[16:19], v[100:103]
    v_mfma_f32_16x16x32_bf16 v[100:103], v[132:135], v[20:23], v[100:103]
    buffer_load_dwordx4 v231, s[24:27], s6 offen offset:3072 lds
    s_cmp_eq_u32 s62, 0
    s_cbranch_scc1 L_sa_26
    s_barrier
    s_branch L_se_27
L_sa_26:
    s_waitcnt vmcnt(12)
    v_cmp_ne_u32 vcc, s68, v235
    s_nop 0
    s_and_b64 vcc, vcc, 0xf
    s_cbranch_scc0 L_pk_28
    s_add_u32 s4, s49, 4096
    s_mov_b64 exec, 0xf
    s_mov_b32 s7, 0
L_poll_29:
    buffer_load_dword v235, v232, s[16:19], s4 offen offset:0 sc1
    s_add_u32 s7, s7, 1
    s_cmp_gt_u32 s7, 200000
    s_cbranch_scc1 L_polld_30
    s_waitcnt vmcnt(0)
    v_cmp_ne_u32 vcc, s68, v235
    s_nop 0
    s_cbranch_vccz L_polld_30
    s_sleep 6
    s_branch L_poll_29
L_polld_30:
    s_waitcnt vmcnt(0)
    s_mov_b64 exec, -1
L_pk_28:
L_se_27:
    s_add_u32 s6, s44, 4
    s_lshl_b32 s6, s6, 12
    s_add_u32 s6, s6, s46
    buffer_load_dwordx4 v[136:139], v251, s[16:19], s6 offen offset:0 sc1
    buffer_load_dwordx4 v[140:143], v251, s[16:19], s6 offen offset:1024 sc1
    buffer_load_dwordx4 v[144:147], v251, s[16:19], s6 offen offset:2048 sc1
    buffer_load_dwordx4 v[148:151], v251, s[16:19], s6 offen offset:3072 sc1
    s_add_u32 s6, s45, 4
    s_lshl_b32 s6, s6, 12
    s_add_u32 s6, s6, s46
    buffer_load_dwordx4 v[152:155], v251, s[16:19], s6 offen offset:0 sc1
    buffer_load_dwordx4 v[156:159], v251, s[16:19], s6 offen offset:1024 sc1
    buffer_load_dwordx4 v[160:163], v251, s[16:19], s6 offen offset:2048 sc1
    buffer_load_dwordx4 v[164:167], v251, s[16:19], s6 offen offset:3072 sc1
    s_mov_b64 exec, s[72:73]
    s_add_u32 s6, s44, 5
    s_lshl_b32 s6, s6, 12
    s_add_u32 s6, s6, s46
    buffer_load_dwordx4 v[168:171], v251, s[16:19], s6 offen offset:0 sc1
    s_mov_b64 exec, -1
    s_mov_b64 exec, s[72:73]
    buffer_load_dwordx4 v[172:175], v251, s[16:19], s6 offen offset:1024 sc1
    s_mov_b64 exec, -1
    s_mov_b64 exec, s[72:73]
    buffer_load_dwordx4 v[176:179], v251, s[16:19], s6 offen offset:2048 sc1
    s_mov_b64 exec, -1
    s_mov_b64 exec, s[72:73]
    buffer_load_dwordx4 v[180:183], v251, s[16:19], s6 offen offset:3072 sc1
    s_mov_b64 exec, -1
    s_waitcnt vmcnt(4)
    s_waitcnt lgkmcnt(4)
    v_mfma_f32_16x16x32_bf16 v[40:43], v[136:139], v[24:27], v[40:43]
    ds_read_b64_tr_b16 v[16:17], v4 offset:0
    v_mfma_f32_16x16x32_bf16 v[40:43], v[152:155], v[28:31], v[40:43]
    ds_read_b64_tr_b16 v[18:19], v4 offset:512
    v_mfma_f32_16x16x32_bf16 v[44:47], v[140:143], v[24:27], v[44:47]
    ds_read_b64_tr_b16 v[20:21], v8 offset:16384
    v_mfma_f32_16x16x32_bf16 v[44:47], v[156:159], v[28:31], v[44:47]
    ds_read_b64_tr_b16 v[22:23], v8 offset:16896
    s_add_u32 m0, s42, 0
    s_xor_b32 s6, s79, 3
    s_lshl2_add_u32 s6, s67, s6
    s_lshl_b32 s6, s6, 15
    s_add_u32 s6, s6, s51
    buffer_load_dwordx4 v228, s[24:27], s6 offen offset:0 lds
    v_mfma_f32_16x16x32_bf16 v[48:51], v[144:147], v[24:27], v[48:51]
    v_mfma_f32_16x16x32_bf16 v[48:51], v[160:163], v[28:31], v[48:51]
    v_mfma_f32_16x16x32_bf16 v[52:55], v[148:151], v[24:27], v[52:55]
    v_mfma_f32_16x16x32_bf16 v[52:55], v[164:167], v[28:31], v[52:55]
    buffer_load_dwordx4 v229, s[24:27], s6 offen offset:1024 lds
    s_waitcnt lgkmcnt(4)
    v_mfma_f32_16x16x32_bf16 v[56:59], v[136:139], v[32:35], v[56:59]
    ds_read_b64_tr_b16 v[24:25], v5 offset:0
    v_mfma_f32_16x16x32_bf16 v[56:59], v[152:155], v[36:39], v[56:59]
    ds_read_b64_tr_b16 v[26:27], v5 offset:512
    v_mfma_f32_16x16x32_bf16 v[60:63], v[140:143], v[32:35], v[60:63]
    ds_read_b64_tr_b16 v[28:29], v9 offset:16384
    v_mfma_f32_16x16x32_bf16 v[60:63], v[156:159], v[36:39], v[60:63]
    ds_read_b64_tr_b16 v[30:31], v9 offset:16896
    buffer_load_dwordx4 v230, s[24:27], s6 offen offset:2048 lds
    v_mfma_f32_16x16x32_bf16 v[64:67], v[144:147], v[32:35], v[64:67]
    v_mfma_f32_16x16x32_bf16 v[64:67], v[160:163], v[36:39], v[64:67]
    v_mfma_f32_16x16x32_bf16 v[68:71], v[148:151], v[32:35], v[68:71]
    v_mfma_f32_16x16x32_bf16 v[68:71], v[164:167], v[36:39], v[68:71]
    buffer_load_dwordx4 v231, s[24:27], s6 offen offset:3072 lds
    s_waitcnt lgkmcnt(4)
    v_mfma_f32_16x16x32_bf16 v[72:75], v[136:139], v[16:19], v[72:75]
    ds_read_b64_tr_b16 v[32:33], v6 offset:0
    v_mfma_f32_16x16x32_bf16 v[72:75], v[152:155], v[20:23], v[72:75]
    ds_read_b64_tr_b16 v[34:35], v6 offset:512
    v_mfma_f32_16x16x32_bf16 v[76:79], v[140:143], v[16:19], v[76:79]
    v_mfma_f32_16x16x32_bf16 v[76:79], v[156:159], v[20:23], v[76:79]
    s_barrier
    v_mfma_f32_16x16x32_bf16 v[80:83], v[144:147], v[16:19], v[80:83]
    v_mfma_f32_16x16x32_bf16 v[80:83], v[160:163], v[20:23], v[80:83]
    v_mfma_f32_16x16x32_bf16 v[84:87], v[148:151], v[16:19], v[84:87]
    v_mfma_f32_16x16x32_bf16 v[84:87], v[164:167], v[20:23], v[84:87]
    buffer_load_dwordx4 v[104:107], v251, s[16:19], s52 offen offset:0 sc1
    buffer_load_dwordx4 v[108:111], v251, s[16:19], s53 offen offset:0 sc1
    s_waitcnt lgkmcnt(2)
    v_mfma_f32_16x16x32_bf16 v[88:91], v[136:139], v[24:27], v[88:91]
    ds_read_b64_tr_b16 v[16:17], v7 offset:0
    v_mfma_f32_16x16x32_bf16 v[88:91], v[152:155], v[28:31], v[88:91]
    ds_read_b64_tr_b16 v[18:19], v7 offset:512
    v_mfma_f32_16x16x32_bf16 v[92:95], v[140:143], v[24:27], v[92:95]
    v_mfma_f32_16x16x32_bf16 v[92:95], v[156:159], v[28:31], v[92:95]
    buffer_load_dwordx4 v[112:115], v251, s[16:19], s54 offen offset:0 sc1
    v_mfma_f32_16x16x32_bf16 v[96:99], v[144:147], v[24:27], v[96:99]
    v_mfma_f32_16x16x32_bf16 v[96:99], v[160:163], v[28:31], v[96:99]
    v_mfma_f32_16x16x32_bf16 v[100:103], v[148:151], v[24:27], v[100:103]
    v_mfma_f32_16x16x32_bf16 v[100:103], v[164:167], v[28:31], v[100:103]
    buffer_load_dwordx4 v[116:119], v251, s[16:19], s55 offen offset:0 sc1
    s_waitcnt vmcnt(8)
    s_waitcnt lgkmcnt(2)
    ds_read_b64_tr_b16 v[24:25], v8 offset:0
    ds_read_b64_tr_b16 v[26:27], v8 offset:512
    s_cmp_eq_u32 s67, 3
    s_cbranch_scc1 L_skip_31
    v_mfma_f32_16x16x32_bf16 v[40:43], v[168:171], v[32:35], v[40:43]
    v_mfma_f32_16x16x32_bf16 v[44:47], v[172:175], v[32:35], v[44:47]
    v_mfma_f32_16x16x32_bf16 v[48:51], v[176:179], v[32:35], v[48:51]
    v_mfma_f32_16x16x32_bf16 v[52:55], v[180:183], v[32:35], v[52:55]
L_skip_31:
    buffer_load_dwordx4 v[120:123], v251, s[16:19], s52 offen offset:1024 sc1
    s_waitcnt lgkmcnt(2)
    ds_read_b64_tr_b16 v[32:33], v9 offset:0
    ds_read_b64_tr_b16 v[34:35], v9 offset:512
    s_cmp_eq_u32 s67, 3
    s_cbranch_scc1 L_skip_32
    v_mfma_f32_16x16x32_bf16 v[56:59], v[168:171], v[16:19], v[56:59]
    v_mfma_f32_16x16x32_bf16 v[60:63], v[172:175], v[16:19], v[60:63]
    v_mfma_f32_16x16x32_bf16 v[64:67], v[176:179], v[16:19], v[64:67]
    v_mfma_f32_16x16x32_bf16 v[68:71], v[180:183], v[16:19], v[68:71]
L_skip_32:
    buffer_load_dwordx4 v[124:127], v251, s[16:19], s53 offen offset:1024 sc1
    s_waitcnt lgkmcnt(2)
    s_cmp_eq_u32 s67, 3
    s_cbranch_scc1 L_skip_33
    v_mfma_f32_16x16x32_bf16 v[72:75], v[168:171], v[24:27], v[72:75]
    v_mfma_f32_16x16x32_bf16 v[76:79], v[172:175], v[24:27], v[76:79]
    v_mfma_f32_16x16x32_bf16 v[80:83], v[176:179], v[24:27], v[80:83]
    v_mfma_f32_16x16x32_bf16 v[84:87], v[180:183], v[24:27], v[84:87]
L_skip_33:
    buffer_load_dwordx4 v[128:131], v251, s[16:19], s54 offen offset:1024 sc1
    s_waitcnt lgkmcnt(0)
    s_cmp_eq_u32 s67, 3
    s_cbranch_scc1 L_skip_34
    v_mfma_f32_16x16x32_bf16 v[88:91], v[168:171], v[32:35], v[88:91]
    v_mfma_f32_16x16x32_bf16 v[92:95], v[172:175], v[32:35], v[92:95]
    v_mfma_f32_16x16x32_bf16 v[96:99], v[176:179], v[32:35], v[96:99]
    v_mfma_f32_16x16x32_bf16 v[100:103], v[180:183], v[32:35], v[100:103]
L_skip_34:
    buffer_load_dwordx4 v[132:135], v251, s[16:19], s55 offen offset:1024 sc1
    s_waitcnt vmcnt(8)
    ds_read_b64_tr_b16 v[184:185], v3 offset:16384
    ds_read_b64_tr_b16 v[186:187], v3 offset:16896
    ds_read_b64_tr_b16 v[188:189], v3 offset:32768
    ds_read_b64_tr_b16 v[190:191], v3 offset:33280
    ds_read_b64_tr_b16 v[192:193], v3 offset:49152
    ds_read_b64_tr_b16 v[194:195], v3 offset:49664
    ds_read_b64_tr_b16 v[196:197], v237 offset:0
    ds_read_b64_tr_b16 v[198:199], v237 offset:512
    buffer_load_dwordx4 v[136:139], v251, s[16:19], s52 offen offset:2048 sc1
    ds_read_b64_tr_b16 v[200:201], v4 offset:16384
    ds_read_b64_tr_b16 v[202:203], v4 offset:16896
    ds_read_b64_tr_b16 v[204:205], v4 offset:32768
    ds_read_b64_tr_b16 v[206:207], v4 offset:33280
    ds_read_b64_tr_b16 v[208:209], v4 offset:49152
    ds_read_b64_tr_b16 v[210:211], v4 offset:49664
    ds_read_b64_tr_b16 v[212:213], v238 offset:0
    ds_read_b64_tr_b16 v[214:215], v238 offset:512
    buffer_load_dwordx4 v[140:143], v251, s[16:19], s53 offen offset:2048 sc1
    ds_read_b64_tr_b16 v[216:217], v5 offset:16384
    ds_read_b64_tr_b16 v[218:219], v5 offset:16896
    ds_read_b64_tr_b16 v[220:221], v5 offset:32768
    ds_read_b64_tr_b16 v[222:223], v5 offset:33280
    ds_read_b64_tr_b16 v[224:225], v5 offset:49152
    ds_read_b64_tr_b16 v[226:227], v5 offset:49664
    ds_read_b64_tr_b16 v[228:229], v239 offset:0
    ds_read_b64_tr_b16 v[230:231], v239 offset:512
    buffer_load_dwordx4 v[144:147], v251, s[16:19], s54 offen offset:2048 sc1
    buffer_load_dwordx4 v[148:151], v251, s[16:19], s55 offen offset:2048 sc1
    s_waitcnt lgkmcnt(0)
    ds_read_b64_tr_b16 v[168:169], v2 offset:16384
    ds_read_b64_tr_b16 v[170:171], v2 offset:16896
    ds_read_b64_tr_b16 v[172:173], v2 offset:32768
    ds_read_b64_tr_b16 v[174:175], v2 offset:33280
    ds_read_b64_tr_b16 v[176:177], v2 offset:49152
    ds_read_b64_tr_b16 v[178:179], v2 offset:49664
    ds_read_b64_tr_b16 v[180:181], v236 offset:0
    ds_read_b64_tr_b16 v[182:183], v236 offset:512
    s_waitcnt vmcnt(8)
    v_max3_u32 v12, v107, v111, v115
    v_max_u32 v12, v12, v119
    v_cmp_eq_u32 vcc, -1, v12
    s_nop 0
    s_and_b64 vcc, vcc, s[0:1]
    s_cbranch_vccnz L_vs_36
L_vc_35:
    v_mfma_f32_16x16x32_bf16 v[56:59], v[104:107], v[184:187], v[56:59]
    v_mfma_f32_16x16x32_bf16 v[56:59], v[108:111], v[188:191], v[56:59]
    buffer_load_dwordx4 v[152:155], v251, s[16:19], s52 offen offset:3072 sc1
    v_mfma_f32_16x16x32_bf16 v[56:59], v[112:115], v[192:195], v[56:59]
    v_mfma_f32_16x16x32_bf16 v[56:59], v[116:119], v[196:199], v[56:59]
    buffer_load_dwordx4 v[156:159], v251, s[16:19], s53 offen offset:3072 sc1
    v_mfma_f32_16x16x32_bf16 v[72:75], v[104:107], v[200:203], v[72:75]
    v_mfma_f32_16x16x32_bf16 v[72:75], v[108:111], v[204:207], v[72:75]
    buffer_load_dwordx4 v[160:163], v251, s[16:19], s54 offen offset:3072 sc1
    v_mfma_f32_16x16x32_bf16 v[72:75], v[112:115], v[208:211], v[72:75]
    v_mfma_f32_16x16x32_bf16 v[72:75], v[116:119], v[212:215], v[72:75]
    buffer_load_dwordx4 v[164:167], v251, s[16:19], s55 offen offset:3072 sc1
    s_waitcnt lgkmcnt(0)
    v_mfma_f32_16x16x32_bf16 v[88:91], v[104:107], v[216:219], v[88:91]
    s_add_u32 m0, s42, 0
    s_nop 0
    ds_write_addtid_b32 v56 offset:272
    v_mfma_f32_16x16x32_bf16 v[88:91], v[108:111], v[220:223], v[88:91]
    ds_write_addtid_b32 v57 offset:1616
    v_mfma_f32_16x16x32_bf16 v[88:91], v[112:115], v[224:227], v[88:91]
    ds_write_addtid_b32 v58 offset:16784
    v_mfma_f32_16x16x32_bf16 v[88:91], v[116:119], v[228:231], v[88:91]
    ds_write_addtid_b32 v59 offset:18128
    s_waitcnt vmcnt(8)
    v_max3_u32 v12, v123, v127, v131
    v_max_u32 v12, v12, v135
    v_cmp_eq_u32 vcc, -1, v12
    s_nop 0
    s_and_b64 vcc, vcc, s[0:1]
    v_mfma_f32_16x16x32_bf16 v[40:43], v[104:107], v[168:171], v[40:43]
    ds_write_addtid_b32 v72 offset:768
    v_mfma_f32_16x16x32_bf16 v[40:43], v[108:111], v[172:175], v[40:43]
    ds_write_addtid_b32 v73 offset:2112
    v_mfma_f32_16x16x32_bf16 v[40:43], v[112:115], v[176:179], v[40:43]
    ds_write_addtid_b32 v74 offset:17280
    v_mfma_f32_16x16x32_bf16 v[40:43], v[116:119], v[180:183], v[40:43]
    ds_write_addtid_b32 v75 offset:18624
    s_cbranch_vccnz L_vs_38
L_vc_37:
    v_mfma_f32_16x16x32_bf16 v[60:63], v[120:123], v[184:187], v[60:63]
    ds_write_addtid_b32 v88 offset:1040
    v_mfma_f32_16x16x32_bf16 v[60:63], v[124:127], v[188:191], v[60:63]
    ds_write_addtid_b32 v89 offset:2384
    v_mfma_f32_16x16x32_bf16 v[60:63], v[128:131], v[192:195], v[60:63]
    ds_write_addtid_b32 v90 offset:17552
    v_mfma_f32_16x16x32_bf16 v[60:63], v[132:135], v[196:199], v[60:63]
    ds_write_addtid_b32 v91 offset:18896
    v_mfma_f32_16x16x32_bf16 v[76:79], v[120:123], v[200:203], v[76:79]
    ds_write_addtid_b32 v40 offset:0
    v_mfma_f32_16x16x32_bf16 v[76:79], v[124:127], v[204:207], v[76:79]
    ds_write_addtid_b32 v41 offset:1344
    v_mfma_f32_16x16x32_bf16 v[76:79], v[128:131], v[208:211], v[76:79]
    ds_write_addtid_b32 v42 offset:16512
    v_mfma_f32_16x16x32_bf16 v[76:79], v[132:135], v[212:215], v[76:79]
    ds_write_addtid_b32 v43 offset:17856
    v_mfma_f32_16x16x32_bf16 v[92:95], v[120:123], v[216:219], v[92:95]
    ds_write_addtid_b32 v60 offset:33040
    v_mfma_f32_16x16x32_bf16 v[92:95], v[124:127], v[220:223], v[92:95]
    ds_write_addtid_b32 v61 offset:34384
    v_mfma_f32_16x16x32_bf16 v[92:95], v[128:131], v[224:227], v[92:95]
    ds_write_addtid_b32 v62 offset:49552
    v_mfma_f32_16x16x32_bf16 v[92:95], v[132:135], v[228:231], v[92:95]
    ds_write_addtid_b32 v63 offset:50896
    s_waitcnt vmcnt(4)
    v_max3_u32 v12, v139, v143, v147
    v_max_u32 v12, v12, v151
    v_cmp_eq_u32 vcc, -1, v12
    s_nop 0
    s_and_b64 vcc, vcc, s[0:1]
    v_mfma_f32_16x16x32_bf16 v[44:47], v[120:123], v[168:171], v[44:47]
    ds_write_addtid_b32 v76 offset:33536
    v_mfma_f32_16x16x32_bf16 v[44:47], v[124:127], v[172:175], v[44:47]
    ds_write_addtid_b32 v77 offset:34880
    v_mfma_f32_16x16x32_bf16 v[44:47], v[128:131], v[176:179], v[44:47]
    ds_write_addtid_b32 v78 offset:50048
    v_mfma_f32_16x16x32_bf16 v[44:47], v[132:135], v[180:183], v[44:47]
    ds_write_addtid_b32 v79 offset:51392
    s_cbranch_vccnz L_vs_40
L_vc_39:
    v_mfma_f32_16x16x32_bf16 v[64:67], v[136:139], v[184:187], v[64:67]
    ds_write_addtid_b32 v92 offset:33808
    v_mfma_f32_16x16x32_bf16 v[64:67], v[140:143], v[188:191], v[64:67]
    ds_write_addtid_b32 v93 offset:35152
    v_mfma_f32_16x16x32_bf16 v[64:67], v[144:147], v[192:195], v[64:67]
    ds_write_addtid_b32 v94 offset:50320
    v_mfma_f32_16x16x32_bf16 v[64:67], v[148:151], v[196:199], v[64:67]
    ds_write_addtid_b32 v95 offset:51664
    v_mfma_f32_16x16x32_bf16 v[80:83], v[136:139], v[200:203], v[80:83]
    ds_write_addtid_b32 v44 offset:32768
    v_mfma_f32_16x16x32_bf16 v[80:83], v[140:143], v[204:207], v[80:83]
    ds_write_addtid_b32 v45 offset:34112
    v_mfma_f32_16x16x32_bf16 v[80:83], v[144:147], v[208:211], v[80:83]
    ds_write_addtid_b32 v46 offset:49280
    v_mfma_f32_16x16x32_bf16 v[80:83], v[148:151], v[212:215], v[80:83]
    ds_write_addtid_b32 v47 offset:50624
    v_mfma_f32_16x16x32_bf16 v[96:99], v[136:139], v[216:219], v[96:99]
    s_add_u32 m0, s42, 53000
    s_nop 0
    ds_write_addtid_b32 v64 offset:12808
    v_mfma_f32_16x16x32_bf16 v[96:99], v[140:143], v[220:223], v[96:99]
    ds_write_addtid_b32 v65 offset:14152
    v_mfma_f32_16x16x32_bf16 v[96:99], v[144:147], v[224:227], v[96:99]
    ds_write_addtid_b32 v66 offset:29320
    v_mfma_f32_16x16x32_bf16 v[96:99], v[148:151], v[228:231], v[96:99]
    ds_write_addtid_b32 v67 offset:30664
    s_waitcnt vmcnt(0)
    v_max3_u32 v12, v155, v159, v163
    v_max_u32_e64 v12, v12, v167
    v_cmp_eq_u32 vcc, -1, v12
    s_nop 0
    s_and_b64 vcc, vcc, s[0:1]
    v_mfma_f32_16x16x32_bf16 v[48:51], v[136:139], v[168:171], v[48:51]
    ds_write_addtid_b32 v80 offset:13304
    v_mfma_f32_16x16x32_bf16 v[48:51], v[140:143], v[172:175], v[48:51]
    ds_write_addtid_b32 v81 offset:14648
    v_mfma_f32_16x16x32_bf16 v[48:51], v[144:147], v[176:179], v[48:51]
    ds_write_addtid_b32 v82 offset:29816
    v_mfma_f32_16x16x32_bf16 v[48:51], v[148:151], v[180:183], v[48:51]
    ds_write_addtid_b32 v83 offset:31160
    s_waitcnt lgkmcnt(8)
    s_barrier
    s_cbranch_vccnz L_vs_42
L_vc_41:
    v_mfma_f32_16x16x32_bf16 v[68:71], v[152:155], v[184:187], v[68:71]
    ds_write_addtid_b32 v96 offset:13576
    v_mfma_f32_16x16x32_bf16 v[68:71], v[156:159], v[188:191], v[68:71]
    ds_write_addtid_b32 v97 offset:14920
    v_mfma_f32_16x16x32_bf16 v[68:71], v[160:163], v[192:195], v[68:71]
    ds_write_addtid_b32 v98 offset:30088
    v_mfma_f32_16x16x32_bf16 v[68:71], v[164:167], v[196:199], v[68:71]
    ds_write_addtid_b32 v99 offset:31432
    v_mfma_f32_16x16x32_bf16 v[84:87], v[152:155], v[200:203], v[84:87]
    ds_write_addtid_b32 v48 offset:12536
    v_mfma_f32_16x16x32_bf16 v[84:87], v[156:159], v[204:207], v[84:87]
    ds_write_addtid_b32 v49 offset:13880
    v_mfma_f32_16x16x32_bf16 v[84:87], v[160:163], v[208:211], v[84:87]
    ds_write_addtid_b32 v50 offset:29048
    v_mfma_f32_16x16x32_bf16 v[84:87], v[164:167], v[212:215], v[84:87]
    ds_write_addtid_b32 v51 offset:30392
    v_mfma_f32_16x16x32_bf16 v[100:103], v[152:155], v[216:219], v[100:103]
    ds_write_addtid_b32 v68 offset:45576
    v_mfma_f32_16x16x32_bf16 v[100:103], v[156:159], v[220:223], v[100:103]
    ds_write_addtid_b32 v69 offset:46920
    v_mfma_f32_16x16x32_bf16 v[100:103], v[160:163], v[224:227], v[100:103]
    ds_write_addtid_b32 v70 offset:62088
    v_mfma_f32_16x16x32_bf16 v[100:103], v[164:167], v[228:231], v[100:103]
    ds_write_addtid_b32 v71 offset:63432
    v_mfma_f32_16x16x32_bf16 v[52:55], v[152:155], v[168:171], v[52:55]
    ds_write_addtid_b32 v84 offset:46072
    v_mfma_f32_16x16x32_bf16 v[52:55], v[156:159], v[172:175], v[52:55]
    ds_write_addtid_b32 v85 offset:47416
    v_mfma_f32_16x16x32_bf16 v[52:55], v[160:163], v[176:179], v[52:55]
    ds_write_addtid_b32 v86 offset:62584
    v_mfma_f32_16x16x32_bf16 v[52:55], v[164:167], v[180:183], v[52:55]
    ds_write_addtid_b32 v87 offset:63928
    ds_write_addtid_b32 v100 offset:46344
    ds_write_addtid_b32 v101 offset:47688
    ds_write_addtid_b32 v102 offset:62856
    ds_write_addtid_b32 v103 offset:64200
    s_nop 2
    ds_write_addtid_b32 v52 offset:45304
    ds_write_addtid_b32 v53 offset:46648
    ds_write_addtid_b32 v54 offset:61816
    ds_write_addtid_b32 v55 offset:63160
    s_waitcnt lgkmcnt(0)
    s_barrier
    ds_read_b128 v[104:107], v255 offset:0
    ds_read_b128 v[108:111], v255 offset:16
    ds_read_b128 v[112:115], v255 offset:4096
    ds_read_b128 v[116:119], v255 offset:4112
    ds_read_b128 v[120:123], v255 offset:8192
    ds_read_b128 v[124:127], v255 offset:8208
    ds_read_b128 v[128:131], v255 offset:12288
    ds_read_b128 v[132:135], v255 offset:12304
    s_waitcnt lgkmcnt(6)
    v_pk_add_f32 v[240:241], v[240:241], v[104:105]
    v_pk_add_f32 v[242:243], v[242:243], v[106:107]
    v_pk_add_f32 v[244:245], v[244:245], v[108:109]
    v_pk_add_f32 v[246:247], v[246:247], v[110:111]
    s_waitcnt lgkmcnt(4)
    v_pk_add_f32 v[240:241], v[240:241], v[112:113]
    v_pk_add_f32 v[242:243], v[242:243], v[114:115]
    v_pk_add_f32 v[244:245], v[244:245], v[116:117]
    v_pk_add_f32 v[246:247], v[246:247], v[118:119]
    s_waitcnt lgkmcnt(2)
    v_pk_add_f32 v[240:241], v[240:241], v[120:121]
    v_pk_add_f32 v[242:243], v[242:243], v[122:123]
    v_pk_add_f32 v[244:245], v[244:245], v[124:125]
    v_pk_add_f32 v[246:247], v[246:247], v[126:127]
    s_waitcnt lgkmcnt(0)
    v_pk_add_f32 v[240:241], v[240:241], v[128:129]
    v_pk_add_f32 v[242:243], v[242:243], v[130:131]
    v_pk_add_f32 v[244:245], v[244:245], v[132:133]
    v_pk_add_f32 v[246:247], v[246:247], v[134:135]
    v_cvt_pk_bf16_f32 v16, v240, v241
    v_cvt_pk_bf16_f32 v17, v242, v243
    v_cvt_pk_bf16_f32 v18, v244, v245
    v_cvt_pk_bf16_f32 v19, v246, v247
    buffer_store_dwordx4 v[16:19], v248, s[28:31], 0 offen sc1
L_done:
L_end:
    s_endpgm
L_vs_36:
    s_add_u32 s3, s3, 1
    s_cmp_gt_u32 s3, 200000
    s_cselect_b64 s[0:1], 0, s[0:1]
    buffer_load_dwordx4 v[104:107], v251, s[16:19], s52 offen offset:0 sc1
    buffer_load_dwordx4 v[108:111], v251, s[16:19], s53 offen offset:0 sc1
    buffer_load_dwordx4 v[112:115], v251, s[16:19], s54 offen offset:0 sc1
    buffer_load_dwordx4 v[116:119], v251, s[16:19], s55 offen offset:0 sc1
    s_waitcnt vmcnt(0)
    v_max3_u32 v12, v107, v111, v115
    v_max_u32_e64 v12, v12, v119
    v_cmp_eq_u32 vcc, -1, v12
    s_nop 0
    s_and_b64 vcc, vcc, s[0:1]
    s_cbranch_scc1 L_vs_36
    buffer_load_dwordx4 v[120:123], v251, s[16:19], s52 offen offset:1024 sc1
    buffer_load_dwordx4 v[124:127], v251, s[16:19], s53 offen offset:1024 sc1
    buffer_load_dwordx4 v[128:131], v251, s[16:19], s54 offen offset:1024 sc1
    buffer_load_dwordx4 v[132:135], v251, s[16:19], s55 offen offset:1024 sc1
    buffer_load_dwordx4 v[136:139], v251, s[16:19], s52 offen offset:2048 sc1
    buffer_load_dwordx4 v[140:143], v251, s[16:19], s53 offen offset:2048 sc1
    buffer_load_dwordx4 v[144:147], v251, s[16:19], s54 offen offset:2048 sc1
    buffer_load_dwordx4 v[148:151], v251, s[16:19], s55 offen offset:2048 sc1
    s_branch L_vc_35
L_vs_38:
    s_add_u32 s3, s3, 1
    s_cmp_gt_u32 s3, 200000
    s_cselect_b64 s[0:1], 0, s[0:1]
    buffer_load_dwordx4 v[120:123], v251, s[16:19], s52 offen offset:1024 sc1
    buffer_load_dwordx4 v[124:127], v251, s[16:19], s53 offen offset:1024 sc1
    buffer_load_dwordx4 v[128:131], v251, s[16:19], s54 offen offset:1024 sc1
    buffer_load_dwordx4 v[132:135], v251, s[16:19], s55 offen offset:1024 sc1
    s_waitcnt vmcnt(0)
    v_max3_u32 v12, v123, v127, v131
    v_max_u32_e64 v12, v12, v135
    v_cmp_eq_u32 vcc, -1, v12
    s_nop 0
    s_and_b64 vcc, vcc, s[0:1]
    s_cbranch_scc1 L_vs_38
    buffer_load_dwordx4 v[136:139], v251, s[16:19], s52 offen offset:2048 sc1
    buffer_load_dwordx4 v[140:143], v251, s[16:19], s53 offen offset:2048 sc1
    buffer_load_dwordx4 v[144:147], v251, s[16:19], s54 offen offset:2048 sc1
    buffer_load_dwordx4 v[148:151], v251, s[16:19], s55 offen offset:2048 sc1
    buffer_load_dwordx4 v[152:155], v251, s[16:19], s52 offen offset:3072 sc1
    buffer_load_dwordx4 v[156:159], v251, s[16:19], s53 offen offset:3072 sc1
    buffer_load_dwordx4 v[160:163], v251, s[16:19], s54 offen offset:3072 sc1
    buffer_load_dwordx4 v[164:167], v251, s[16:19], s55 offen offset:3072 sc1
    s_branch L_vc_37
L_vs_40:
    s_add_u32 s3, s3, 1
    s_cmp_gt_u32 s3, 200000
    s_cselect_b64 s[0:1], 0, s[0:1]
    buffer_load_dwordx4 v[136:139], v251, s[16:19], s52 offen offset:2048 sc1
    buffer_load_dwordx4 v[140:143], v251, s[16:19], s53 offen offset:2048 sc1
    buffer_load_dwordx4 v[144:147], v251, s[16:19], s54 offen offset:2048 sc1
    buffer_load_dwordx4 v[148:151], v251, s[16:19], s55 offen offset:2048 sc1
    s_waitcnt vmcnt(0)
    v_max3_u32 v12, v139, v143, v147
    v_max_u32_e64 v12, v12, v151
    v_cmp_eq_u32 vcc, -1, v12
    s_nop 0
    s_and_b64 vcc, vcc, s[0:1]
    s_cbranch_scc1 L_vs_40
    buffer_load_dwordx4 v[152:155], v251, s[16:19], s52 offen offset:3072 sc1
    buffer_load_dwordx4 v[156:159], v251, s[16:19], s53 offen offset:3072 sc1
    buffer_load_dwordx4 v[160:163], v251, s[16:19], s54 offen offset:3072 sc1
    buffer_load_dwordx4 v[164:167], v251, s[16:19], s55 offen offset:3072 sc1
    s_branch L_vc_39
L_vs_42:
    s_add_u32 s3, s3, 1
    s_cmp_gt_u32 s3, 200000
    s_cselect_b64 s[0:1], 0, s[0:1]
    buffer_load_dwordx4 v[152:155], v251, s[16:19], s52 offen offset:3072 sc1
    buffer_load_dwordx4 v[156:159], v251, s[16:19], s53 offen offset:3072 sc1
    buffer_load_dwordx4 v[160:163], v251, s[16:19], s54 offen offset:3072 sc1
    buffer_load_dwordx4 v[164:167], v251, s[16:19], s55 offen offset:3072 sc1
    s_waitcnt vmcnt(0)
    v_max3_u32 v12, v155, v159, v163
    v_max_u32 v12, v12, v167
    v_cmp_eq_u32 vcc, -1, v12
    s_nop 0
    s_and_b64 vcc, vcc, s[0:1]
    s_cbranch_scc1 L_vs_42
    s_branch L_vc_41
L_codeend:
    .fill (33024-(L_codeend-L_start))/4, 4, 0xbf810000

.section .rodata,"a"
.p2align 6
.amdhsa_kernel parallel_sum__linear_kernel_hedgehog__dense_activation_gelu__prompt_kernel
  .amdhsa_next_free_vgpr 256
  .amdhsa_next_free_sgpr 102
  .amdhsa_accum_offset 256
  .amdhsa_group_segment_fixed_size 0
  .amdhsa_kernarg_size 96
  .amdhsa_user_sgpr_count 2
  .amdhsa_user_sgpr_kernarg_segment_ptr 1
  .amdhsa_system_sgpr_workgroup_id_x 1
  .amdhsa_float_denorm_mode_32 3
.end_amdhsa_kernel
```
